```python
import torch

def _softmax(x, axis=-1):
    return torch.softmax(x, dim=axis)

def _gelu(x):
    return torch.nn.functional.gelu(x, approximate='tanh')

def _silu(x):
    return torch.nn.functional.silu(x)

def _sigmoid(x):
    return torch.sigmoid(x)

def _layernorm(x, axis=-1, eps=1e-05):
    m = x.mean(dim=axis, keepdim=True)
    v = x.var(dim=axis, keepdim=True, unbiased=False)
    return (x - m) / torch.sqrt(v + eps)

def _scatter_add(tgt, idx, src, axis=0):
    return tgt.clone().index_add_(axis, idx, src)

def _segment_sum(src, seg, n):
    out = torch.zeros((n,) + src.shape[1:], dtype=src.dtype)
    return out.index_add_(0, seg, src)

def _pad(x, pw):
    flat = tuple((v for pair in reversed(pw) for v in pair))
    return torch.nn.functional.pad(x, flat)
kernel_name = 'adaLN_cond__gqa_block_cached__dense_activation_relu__decode'

def setup_inputs():

    _w = lambda a: (lambda t: t.to(torch.bfloat16) if t.is_floating_point() else t)(torch.as_tensor(a))

    def _A_setup():
        B, Sq, D = (4, 1, 448)
        Hq, Hkv, Sk, Dh = (16, 8, 4096, 256)
        assert Hq % Hkv == 0, (Hq, Hkv)
        return {'x': _w((lambda *s: torch.randn(*s, dtype=torch.bfloat16) * 0.05)(B, Sq, D)), 'k_cache': _w((lambda *s: torch.randn(*s, dtype=torch.bfloat16) * 3.2)(B, Hkv, Sk, Dh)), 'v_cache': _w((lambda *s: torch.randn(*s, dtype=torch.bfloat16) * 0.4)(B, Hkv, Sk, Dh)), 'wq': _w((lambda *s: torch.randn(*s, dtype=torch.bfloat16) * 3.2)(D, Hq * Dh) * D ** (-0.5)), 'wo': _w((lambda *s: torch.randn(*s, dtype=torch.bfloat16) * 0.4)(Hq * Dh, D) * (Hq * Dh) ** (-0.5))}
    _A_in = _A_setup()

    def _B_setup():
        B, S, D, Dff = (4, 1, 448, 1792)
        return {'x': _w((lambda *s: torch.randn(*s, dtype=torch.bfloat16) * 0.05)(B, S, D)), 'w1': _w((lambda *s: torch.randn(*s, dtype=torch.bfloat16) * 0.05)(D, Dff)), 'w2': _w((lambda *s: torch.randn(*s, dtype=torch.bfloat16) * 0.05)(Dff, D))}
    _B_in = _B_setup()
    return {'A_x': _A_in['x'], 'A_k_cache': _A_in['k_cache'], 'A_v_cache': _A_in['v_cache'], 'A_wq': _A_in['wq'], 'A_wo': _A_in['wo'], 'B_x': _B_in['x'], 'B_w1': _B_in['w1'], 'B_w2': _B_in['w2'], 'c': _w((lambda *s: torch.randn(*s, dtype=torch.bfloat16) * 0.2)(4, 448) * 8.0), 'w_mod': _w((lambda *s: torch.randn(*s, dtype=torch.bfloat16) * 0.2)(448, 6 * 448) * 448 ** (-0.5) * 8.0)}

def reference(A_x, A_k_cache, A_v_cache, A_wq, A_wo, B_x, B_w1, B_w2, c, w_mod):

    def _A_ref(x, k_cache, v_cache, wq, wo):
        B, Sq, D = x.shape
        Hq, Dh = (16, 256)
        Hkv = k_cache.shape[1]
        rep = Hq // Hkv
        q = (lambda x, *d: x.permute(*d))((x @ wq).reshape(B, Sq, Hq, Dh), 0, 2, 1, 3)
        k = (lambda x, n, axis: torch.repeat_interleave(x, n, dim=axis))(k_cache, rep, axis=1)
        v = (lambda x, n, axis: torch.repeat_interleave(x, n, dim=axis))(v_cache, rep, axis=1)
        scores = torch.einsum('bhqd,bhkd->bhqk', q, k) * Dh ** (-0.5)
        p = _softmax(scores, axis=-1)
        o = torch.einsum('bhqk,bhkd->bhqd', p, v)
        return (lambda x, *d: x.permute(*d))(o, 0, 2, 1, 3).reshape(B, Sq, Hq * Dh) @ wo

    def _B_ref(x, w1, w2):
        h = torch.einsum('bsd,df->bsf', x, w1)
        zero = torch.zeros_like(h)
        h = torch.maximum(h, zero)
        return torch.einsum('bsf,fd->bsd', h, w2)
    x = A_x
    mod = (_silu(c) @ w_mod).reshape(c.shape[0], 6, 1, -1)
    sa, ca, ga, sb, cb, gb = (mod[:, 0].clone(), mod[:, 1].clone(), mod[:, 2].clone(), mod[:, 3].clone(), mod[:, 4].clone(), mod[:, 5].clone())
    h = _layernorm(x, axis=-1) * (1 + ca) + sa
    x = x + ga * _A_ref(h, A_k_cache, A_v_cache, A_wq, A_wo)
    h = _layernorm(x, axis=-1) * (1 + cb) + sb
    x = x + gb * _B_ref(h, B_w1, B_w2)
    return x
```

```asm
; @launch grid=(256,1,1) block=(768,1,1) lds=151808
.amdgcn_target "amdgcn-amd-amdhsa--gfx950"
.text
.p2align 8
.fill 64, 4, 0xbf810000
.globl adaLN_cond__gqa_block_cached__dense_activation_relu__decode_kernel
.p2align 8
.type adaLN_cond__gqa_block_cached__dense_activation_relu__decode_kernel,@function
adaLN_cond__gqa_block_cached__dense_activation_relu__decode_kernel:
s_cmp_ge_u32 s2, 0x100
s_cbranch_scc1 L_END
s_load_dwordx4 s[4:7], s[0:1], 8
v_lshrrev_b32 v1, 6, v0
s_and_b32 s83, s2, 7
s_bfe_u32 s84, s2, 0x30003
s_and_b32 s2, s2, 0xc0
s_lshl_b32 s85, s83, 3
s_or_b32 s2, s2, s85
s_or_b32 s2, s2, s84
s_cmp_lt_u32 s2, 128
s_cselect_b32 s85, 4, 3
s_cmp_lt_u32 s83, 2
s_cselect_b32 s85, 4, s85
v_readfirstlane_b32 s3, v1
v_and_b32 v0, 63, v0
s_cmp_lt_u32 s3, 4
s_cbranch_scc1 L_HELP
s_sub_u32 s26, s3, 4
s_lshl_b32 s20, s2, 18
s_lshl_b32 s21, s26, 13
s_add_u32 s20, s20, s21
v_and_b32 v3, 15, v0
v_lshrrev_b32 v4, 4, v0
v_lshrrev_b32 v5, 2, v3
v_lshlrev_b32 v1, 11, v5
v_lshl_add_u32 v1, v4, 6, v1
v_and_b32 v5, 3, v3
v_lshl_add_u32 v1, v5, 4, v1
v_lshlrev_b32 v2, 11, v4
v_lshl_add_u32 v2, v3, 4, v2
s_add_u32 s21, s20, 65536
s_add_u32 s22, s20, 131072
s_add_u32 s23, s20, 196608
s_lshr_b32 s28, s2, 6
s_lshr_b32 s29, s26, 1
s_xor_b32 s28, s28, s29
s_xor_b32 s29, s28, 0
s_lshl_b32 s29, s29, 9
s_add_u32 s44, s20, s29
s_add_u32 s48, s21, s29
s_add_u32 s52, s22, s29
s_add_u32 s56, s23, s29
s_xor_b32 s29, s28, 1
s_lshl_b32 s29, s29, 9
s_add_u32 s45, s20, s29
s_add_u32 s49, s21, s29
s_add_u32 s53, s22, s29
s_add_u32 s57, s23, s29
s_xor_b32 s29, s28, 2
s_lshl_b32 s29, s29, 9
s_add_u32 s46, s20, s29
s_add_u32 s50, s21, s29
s_add_u32 s54, s22, s29
s_add_u32 s58, s23, s29
s_xor_b32 s29, s28, 3
s_lshl_b32 s29, s29, 9
s_add_u32 s47, s20, s29
s_add_u32 s51, s21, s29
s_add_u32 s55, s22, s29
s_add_u32 s59, s23, s29
s_mov_b32 s10, 0x4000000
s_mov_b32 s11, 0x20000
s_mov_b32 s14, 0x4000000
s_mov_b32 s15, 0x20000
v_lshrrev_b32 v5, 3, v3
v_lshlrev_b32 v12, 9, v5
v_lshl_add_u32 v12, v4, 6, v12
v_and_b32 v6, 3, v3
v_lshl_add_u32 v12, v6, 4, v12
v_mov_b32 v13, 24592
v_lshlrev_b32 v0, 3, v5
s_mov_b32 s27, 0x3db8aa3b
s_waitcnt lgkmcnt(0)
s_mov_b32 s8, s4
s_mov_b32 s9, s5
s_mov_b32 s12, s6
s_mov_b32 s13, s7
s_cmp_lt_u32 s84, s85
s_cselect_b32 s31, 1, 0
s_cmp_lg_u32 s31, 0
buffer_load_dwordx4 v[40:43], v1, s[8:11], s44 offen offset:0 nt
buffer_load_dwordx4 v[44:47], v1, s[8:11], s44 offen offset:256 nt
buffer_load_dwordx4 v[48:51], v1, s[8:11], s45 offen offset:0 nt
s_cbranch_scc1 AD_1
s_waitcnt vmcnt(2)
AD_1:
s_waitcnt vmcnt(3)
buffer_load_dwordx4 v[52:55], v1, s[8:11], s45 offen offset:256 nt
s_cbranch_scc1 AD_2
s_waitcnt vmcnt(2)
AD_2:
s_waitcnt vmcnt(3)
buffer_load_dwordx4 v[56:59], v1, s[8:11], s46 offen offset:0 nt
s_barrier
s_cbranch_scc1 AD_3
s_waitcnt vmcnt(2)
AD_3:
s_waitcnt vmcnt(3)
buffer_load_dwordx4 v[60:63], v1, s[8:11], s46 offen offset:256 nt
s_cbranch_scc1 AD_4
s_waitcnt vmcnt(2)
AD_4:
s_waitcnt vmcnt(3)
buffer_load_dwordx4 v[64:67], v1, s[8:11], s47 offen offset:0 nt
s_cbranch_scc1 AD_5
s_waitcnt vmcnt(2)
AD_5:
s_waitcnt vmcnt(3)
buffer_load_dwordx4 v[68:71], v1, s[8:11], s47 offen offset:256 nt
s_cbranch_scc1 AD_6
s_waitcnt vmcnt(2)
AD_6:
s_waitcnt vmcnt(3)
buffer_load_dwordx4 v[72:75], v1, s[8:11], s48 offen offset:0 nt
s_cbranch_scc1 AD_7
s_waitcnt vmcnt(2)
AD_7:
s_waitcnt vmcnt(3)
buffer_load_dwordx4 v[76:79], v1, s[8:11], s48 offen offset:256 nt
s_cbranch_scc1 AD_8
s_waitcnt vmcnt(2)
AD_8:
s_waitcnt vmcnt(3)
buffer_load_dwordx4 v[80:83], v1, s[8:11], s49 offen offset:0 nt
s_cbranch_scc1 AD_9
s_waitcnt vmcnt(2)
AD_9:
s_waitcnt vmcnt(3)
buffer_load_dwordx4 v[84:87], v1, s[8:11], s49 offen offset:256 nt
s_cbranch_scc1 AD_10
s_waitcnt vmcnt(2)
AD_10:
s_waitcnt vmcnt(3)
buffer_load_dwordx4 v[88:91], v1, s[8:11], s50 offen offset:0 nt
s_cbranch_scc1 AD_11
s_waitcnt vmcnt(2)
AD_11:
s_waitcnt vmcnt(3)
buffer_load_dwordx4 v[92:95], v1, s[8:11], s50 offen offset:256 nt
s_cbranch_scc1 AD_12
s_waitcnt vmcnt(2)
AD_12:
s_waitcnt vmcnt(3)
buffer_load_dwordx4 v[96:99], v1, s[8:11], s51 offen offset:0 nt
s_cbranch_scc1 AD_13
s_waitcnt vmcnt(2)
AD_13:
s_waitcnt vmcnt(3)
buffer_load_dwordx4 v[100:103], v1, s[8:11], s51 offen offset:256 nt
s_cbranch_scc1 AD_14
s_waitcnt vmcnt(2)
AD_14:
s_waitcnt vmcnt(3)
buffer_load_dwordx4 v[104:107], v1, s[8:11], s52 offen offset:0 nt
s_cbranch_scc1 AD_15
s_waitcnt vmcnt(2)
AD_15:
s_waitcnt vmcnt(3)
buffer_load_dwordx4 v[108:111], v1, s[8:11], s52 offen offset:256 nt
s_cbranch_scc1 AD_16
s_waitcnt vmcnt(2)
AD_16:
s_waitcnt vmcnt(3)
buffer_load_dwordx4 v[112:115], v1, s[8:11], s53 offen offset:0 nt
s_cbranch_scc1 AD_17
s_waitcnt vmcnt(2)
AD_17:
s_waitcnt vmcnt(3)
buffer_load_dwordx4 v[116:119], v1, s[8:11], s53 offen offset:256 nt
s_cbranch_scc1 AD_18
s_waitcnt vmcnt(2)
AD_18:
s_waitcnt vmcnt(3)
buffer_load_dwordx4 v[120:123], v1, s[8:11], s54 offen offset:0 nt
s_cbranch_scc1 AD_19
s_waitcnt vmcnt(2)
AD_19:
s_waitcnt vmcnt(3)
buffer_load_dwordx4 v[124:127], v1, s[8:11], s54 offen offset:256 nt
s_cbranch_scc1 AD_20
s_waitcnt vmcnt(2)
AD_20:
s_waitcnt vmcnt(3)
buffer_load_dwordx4 v[128:131], v1, s[8:11], s55 offen offset:0 nt
s_cbranch_scc1 AD_21
s_waitcnt vmcnt(2)
AD_21:
s_waitcnt vmcnt(3)
buffer_load_dwordx4 v[132:135], v1, s[8:11], s55 offen offset:256 nt
s_cbranch_scc1 AD_22
s_waitcnt vmcnt(2)
AD_22:
s_waitcnt vmcnt(3)
buffer_load_dwordx4 v[136:139], v1, s[8:11], s56 offen offset:0 nt
s_cbranch_scc1 AD_23
s_waitcnt vmcnt(2)
AD_23:
s_waitcnt vmcnt(3)
buffer_load_dwordx4 v[140:143], v1, s[8:11], s56 offen offset:256 nt
s_cbranch_scc1 AD_24
s_waitcnt vmcnt(2)
AD_24:
s_waitcnt vmcnt(3)
buffer_load_dwordx4 v[144:147], v1, s[8:11], s57 offen offset:0 nt
s_cbranch_scc1 AD_25
s_waitcnt vmcnt(2)
AD_25:
s_waitcnt vmcnt(3)
buffer_load_dwordx4 v[148:151], v1, s[8:11], s57 offen offset:256 nt
s_cbranch_scc1 AD_26
s_waitcnt vmcnt(2)
AD_26:
s_waitcnt vmcnt(3)
buffer_load_dwordx4 v[152:155], v1, s[8:11], s58 offen offset:0 nt
s_cbranch_scc1 AD_27
s_waitcnt vmcnt(2)
AD_27:
s_waitcnt vmcnt(3)
buffer_load_dwordx4 v[156:159], v1, s[8:11], s58 offen offset:256 nt
s_cbranch_scc1 AD_28
s_waitcnt vmcnt(2)
AD_28:
s_waitcnt vmcnt(3)
buffer_load_dwordx4 v[160:163], v1, s[8:11], s59 offen offset:0 nt
s_cbranch_scc1 AD_29
s_waitcnt vmcnt(2)
AD_29:
s_waitcnt vmcnt(3)
buffer_load_dwordx4 v[164:167], v1, s[8:11], s59 offen offset:256 nt
s_cbranch_scc1 AD_30
s_waitcnt vmcnt(2)
AD_30:
s_waitcnt vmcnt(3)
buffer_load_dwordx4 v[20:23], v2, s[12:15], s44 offen offset:0 nt
s_cbranch_scc1 AD_31
s_waitcnt vmcnt(2)
AD_31:
s_waitcnt vmcnt(3)
buffer_load_dwordx4 v[24:27], v2, s[12:15], s44 offen offset:256 nt
s_cbranch_scc1 AD_32
s_waitcnt vmcnt(2)
AD_32:
s_waitcnt vmcnt(3)
buffer_load_dwordx4 v[28:31], v2, s[12:15], s45 offen offset:0 nt
s_cbranch_scc1 AD_33
s_waitcnt vmcnt(2)
AD_33:
s_waitcnt vmcnt(3)
buffer_load_dwordx4 v[32:35], v2, s[12:15], s45 offen offset:256 nt
s_cbranch_scc1 AD_34
s_waitcnt vmcnt(2)
AD_34:
s_waitcnt vmcnt(3)
buffer_load_dwordx4 v[36:39], v2, s[12:15], s46 offen offset:0 nt
s_mov_b32 s29, 2560000
SW_35:
ds_read_b32 v3, v13
ds_read_b128 v[4:7], v12 offset:23552
ds_read_b128 v[8:11], v12 offset:23808
s_waitcnt lgkmcnt(0)
v_cmp_eq_u32 vcc, 0, v3
s_cbranch_vccz SWD_36
s_sub_u32 s29, s29, 1
s_cbranch_scc0 SW_35
SWD_36:
s_cmp_lg_u32 s31, 0
v_mfma_f32_16x16x32_bf16 v[12:15], v[40:43], v[4:7], 0
v_mfma_f32_16x16x32_bf16 v[12:15], v[44:47], v[8:11], v[12:15]
v_mfma_f32_16x16x32_bf16 v[16:19], v[48:51], v[4:7], 0
v_mfma_f32_16x16x32_bf16 v[16:19], v[52:55], v[8:11], v[16:19]
s_nop 5
v_mov_b32_dpp v3, v12 quad_perm:[0,0,0,0] row_mask:0xf bank_mask:0xf
s_nop 1
v_add_f32_dpp v3, v13, v3 quad_perm:[1,1,1,1] row_mask:0xf bank_mask:0xf
s_nop 1
v_add_f32_dpp v3, v14, v3 quad_perm:[2,2,2,2] row_mask:0xf bank_mask:0xf
s_nop 1
v_add_f32_dpp v3, v15, v3 quad_perm:[3,3,3,3] row_mask:0xf bank_mask:0xf
v_cvt_pk_bf16_f32 v3, v3, v3
v_and_b32 v40, 0xffff0000, v3
v_mfma_f32_16x16x32_bf16 v[12:15], v[56:59], v[4:7], 0
v_mfma_f32_16x16x32_bf16 v[12:15], v[60:63], v[8:11], v[12:15]
v_mov_b32_dpp v3, v16 quad_perm:[0,0,0,0] row_mask:0xf bank_mask:0xf
s_nop 1
v_add_f32_dpp v3, v17, v3 quad_perm:[1,1,1,1] row_mask:0xf bank_mask:0xf
s_nop 1
v_add_f32_dpp v3, v18, v3 quad_perm:[2,2,2,2] row_mask:0xf bank_mask:0xf
s_nop 1
v_add_f32_dpp v3, v19, v3 quad_perm:[3,3,3,3] row_mask:0xf bank_mask:0xf
v_cvt_pk_bf16_f32 v3, v3, v3
v_and_b32 v41, 0xffff0000, v3
v_mfma_f32_16x16x32_bf16 v[16:19], v[64:67], v[4:7], 0
v_mfma_f32_16x16x32_bf16 v[16:19], v[68:71], v[8:11], v[16:19]
v_mov_b32_dpp v3, v12 quad_perm:[0,0,0,0] row_mask:0xf bank_mask:0xf
s_nop 1
v_add_f32_dpp v3, v13, v3 quad_perm:[1,1,1,1] row_mask:0xf bank_mask:0xf
s_nop 1
v_add_f32_dpp v3, v14, v3 quad_perm:[2,2,2,2] row_mask:0xf bank_mask:0xf
s_nop 1
v_add_f32_dpp v3, v15, v3 quad_perm:[3,3,3,3] row_mask:0xf bank_mask:0xf
v_cvt_pk_bf16_f32 v3, v3, v3
v_and_b32 v42, 0xffff0000, v3
s_cbranch_scc1 AD_37
s_waitcnt vmcnt(2)
AD_37:
s_waitcnt vmcnt(3)
buffer_load_dwordx4 v[60:63], v2, s[12:15], s46 offen offset:256 nt
v_mfma_f32_16x16x32_bf16 v[12:15], v[72:75], v[4:7], 0
v_mfma_f32_16x16x32_bf16 v[12:15], v[76:79], v[8:11], v[12:15]
v_mov_b32_dpp v3, v16 quad_perm:[0,0,0,0] row_mask:0xf bank_mask:0xf
s_nop 1
v_add_f32_dpp v3, v17, v3 quad_perm:[1,1,1,1] row_mask:0xf bank_mask:0xf
s_nop 1
v_add_f32_dpp v3, v18, v3 quad_perm:[2,2,2,2] row_mask:0xf bank_mask:0xf
s_nop 1
v_add_f32_dpp v3, v19, v3 quad_perm:[3,3,3,3] row_mask:0xf bank_mask:0xf
v_cvt_pk_bf16_f32 v3, v3, v3
v_and_b32 v43, 0xffff0000, v3
v_mfma_f32_16x16x32_bf16 v[16:19], v[80:83], v[4:7], 0
v_mfma_f32_16x16x32_bf16 v[16:19], v[84:87], v[8:11], v[16:19]
v_mov_b32_dpp v3, v12 quad_perm:[0,0,0,0] row_mask:0xf bank_mask:0xf
s_nop 1
v_add_f32_dpp v3, v13, v3 quad_perm:[1,1,1,1] row_mask:0xf bank_mask:0xf
s_nop 1
v_add_f32_dpp v3, v14, v3 quad_perm:[2,2,2,2] row_mask:0xf bank_mask:0xf
s_nop 1
v_add_f32_dpp v3, v15, v3 quad_perm:[3,3,3,3] row_mask:0xf bank_mask:0xf
v_cvt_pk_bf16_f32 v3, v3, v3
v_and_b32 v44, 0xffff0000, v3
v_mfma_f32_16x16x32_bf16 v[12:15], v[88:91], v[4:7], 0
v_mfma_f32_16x16x32_bf16 v[12:15], v[92:95], v[8:11], v[12:15]
v_mov_b32_dpp v3, v16 quad_perm:[0,0,0,0] row_mask:0xf bank_mask:0xf
s_nop 1
v_add_f32_dpp v3, v17, v3 quad_perm:[1,1,1,1] row_mask:0xf bank_mask:0xf
s_nop 1
v_add_f32_dpp v3, v18, v3 quad_perm:[2,2,2,2] row_mask:0xf bank_mask:0xf
s_nop 1
v_add_f32_dpp v3, v19, v3 quad_perm:[3,3,3,3] row_mask:0xf bank_mask:0xf
v_cvt_pk_bf16_f32 v3, v3, v3
v_and_b32 v45, 0xffff0000, v3
v_mfma_f32_16x16x32_bf16 v[16:19], v[96:99], v[4:7], 0
v_mfma_f32_16x16x32_bf16 v[16:19], v[100:103], v[8:11], v[16:19]
v_mov_b32_dpp v3, v12 quad_perm:[0,0,0,0] row_mask:0xf bank_mask:0xf
s_nop 1
v_add_f32_dpp v3, v13, v3 quad_perm:[1,1,1,1] row_mask:0xf bank_mask:0xf
s_nop 1
v_add_f32_dpp v3, v14, v3 quad_perm:[2,2,2,2] row_mask:0xf bank_mask:0xf
s_nop 1
v_add_f32_dpp v3, v15, v3 quad_perm:[3,3,3,3] row_mask:0xf bank_mask:0xf
v_cvt_pk_bf16_f32 v3, v3, v3
v_and_b32 v46, 0xffff0000, v3
s_cbranch_scc1 AD_38
s_waitcnt vmcnt(2)
AD_38:
s_waitcnt vmcnt(3)
buffer_load_dwordx4 v[64:67], v2, s[12:15], s47 offen offset:0 nt
v_mfma_f32_16x16x32_bf16 v[12:15], v[104:107], v[4:7], 0
v_mfma_f32_16x16x32_bf16 v[12:15], v[108:111], v[8:11], v[12:15]
v_mov_b32_dpp v3, v16 quad_perm:[0,0,0,0] row_mask:0xf bank_mask:0xf
s_nop 1
v_add_f32_dpp v3, v17, v3 quad_perm:[1,1,1,1] row_mask:0xf bank_mask:0xf
s_nop 1
v_add_f32_dpp v3, v18, v3 quad_perm:[2,2,2,2] row_mask:0xf bank_mask:0xf
s_nop 1
v_add_f32_dpp v3, v19, v3 quad_perm:[3,3,3,3] row_mask:0xf bank_mask:0xf
v_cvt_pk_bf16_f32 v3, v3, v3
v_and_b32 v47, 0xffff0000, v3
v_mfma_f32_16x16x32_bf16 v[16:19], v[112:115], v[4:7], 0
v_mfma_f32_16x16x32_bf16 v[16:19], v[116:119], v[8:11], v[16:19]
v_mov_b32_dpp v3, v12 quad_perm:[0,0,0,0] row_mask:0xf bank_mask:0xf
s_nop 1
v_add_f32_dpp v3, v13, v3 quad_perm:[1,1,1,1] row_mask:0xf bank_mask:0xf
s_nop 1
v_add_f32_dpp v3, v14, v3 quad_perm:[2,2,2,2] row_mask:0xf bank_mask:0xf
s_nop 1
v_add_f32_dpp v3, v15, v3 quad_perm:[3,3,3,3] row_mask:0xf bank_mask:0xf
v_cvt_pk_bf16_f32 v3, v3, v3
v_and_b32 v48, 0xffff0000, v3
v_mfma_f32_16x16x32_bf16 v[12:15], v[120:123], v[4:7], 0
v_mfma_f32_16x16x32_bf16 v[12:15], v[124:127], v[8:11], v[12:15]
v_mov_b32_dpp v3, v16 quad_perm:[0,0,0,0] row_mask:0xf bank_mask:0xf
s_nop 1
v_add_f32_dpp v3, v17, v3 quad_perm:[1,1,1,1] row_mask:0xf bank_mask:0xf
s_nop 1
v_add_f32_dpp v3, v18, v3 quad_perm:[2,2,2,2] row_mask:0xf bank_mask:0xf
s_nop 1
v_add_f32_dpp v3, v19, v3 quad_perm:[3,3,3,3] row_mask:0xf bank_mask:0xf
v_cvt_pk_bf16_f32 v3, v3, v3
v_and_b32 v49, 0xffff0000, v3
v_mfma_f32_16x16x32_bf16 v[16:19], v[128:131], v[4:7], 0
v_mfma_f32_16x16x32_bf16 v[16:19], v[132:135], v[8:11], v[16:19]
v_mov_b32_dpp v3, v12 quad_perm:[0,0,0,0] row_mask:0xf bank_mask:0xf
s_nop 1
v_add_f32_dpp v3, v13, v3 quad_perm:[1,1,1,1] row_mask:0xf bank_mask:0xf
s_nop 1
v_add_f32_dpp v3, v14, v3 quad_perm:[2,2,2,2] row_mask:0xf bank_mask:0xf
s_nop 1
v_add_f32_dpp v3, v15, v3 quad_perm:[3,3,3,3] row_mask:0xf bank_mask:0xf
v_cvt_pk_bf16_f32 v3, v3, v3
v_and_b32 v50, 0xffff0000, v3
s_cbranch_scc1 AD_39
s_waitcnt vmcnt(2)
AD_39:
s_waitcnt vmcnt(3)
buffer_load_dwordx4 v[68:71], v2, s[12:15], s47 offen offset:256 nt
v_mfma_f32_16x16x32_bf16 v[12:15], v[136:139], v[4:7], 0
v_mfma_f32_16x16x32_bf16 v[12:15], v[140:143], v[8:11], v[12:15]
v_mov_b32_dpp v3, v16 quad_perm:[0,0,0,0] row_mask:0xf bank_mask:0xf
s_nop 1
v_add_f32_dpp v3, v17, v3 quad_perm:[1,1,1,1] row_mask:0xf bank_mask:0xf
s_nop 1
v_add_f32_dpp v3, v18, v3 quad_perm:[2,2,2,2] row_mask:0xf bank_mask:0xf
s_nop 1
v_add_f32_dpp v3, v19, v3 quad_perm:[3,3,3,3] row_mask:0xf bank_mask:0xf
v_cvt_pk_bf16_f32 v3, v3, v3
v_and_b32 v51, 0xffff0000, v3
v_mfma_f32_16x16x32_bf16 v[16:19], v[144:147], v[4:7], 0
v_mfma_f32_16x16x32_bf16 v[16:19], v[148:151], v[8:11], v[16:19]
v_mov_b32_dpp v3, v12 quad_perm:[0,0,0,0] row_mask:0xf bank_mask:0xf
s_nop 1
v_add_f32_dpp v3, v13, v3 quad_perm:[1,1,1,1] row_mask:0xf bank_mask:0xf
s_nop 1
v_add_f32_dpp v3, v14, v3 quad_perm:[2,2,2,2] row_mask:0xf bank_mask:0xf
s_nop 1
v_add_f32_dpp v3, v15, v3 quad_perm:[3,3,3,3] row_mask:0xf bank_mask:0xf
v_cvt_pk_bf16_f32 v3, v3, v3
v_and_b32 v52, 0xffff0000, v3
v_mfma_f32_16x16x32_bf16 v[12:15], v[152:155], v[4:7], 0
v_mfma_f32_16x16x32_bf16 v[12:15], v[156:159], v[8:11], v[12:15]
v_mov_b32_dpp v3, v16 quad_perm:[0,0,0,0] row_mask:0xf bank_mask:0xf
s_nop 1
v_add_f32_dpp v3, v17, v3 quad_perm:[1,1,1,1] row_mask:0xf bank_mask:0xf
s_nop 1
v_add_f32_dpp v3, v18, v3 quad_perm:[2,2,2,2] row_mask:0xf bank_mask:0xf
s_nop 1
v_add_f32_dpp v3, v19, v3 quad_perm:[3,3,3,3] row_mask:0xf bank_mask:0xf
v_cvt_pk_bf16_f32 v3, v3, v3
v_and_b32 v53, 0xffff0000, v3
v_mfma_f32_16x16x32_bf16 v[16:19], v[160:163], v[4:7], 0
v_mfma_f32_16x16x32_bf16 v[16:19], v[164:167], v[8:11], v[16:19]
v_mov_b32_dpp v3, v12 quad_perm:[0,0,0,0] row_mask:0xf bank_mask:0xf
s_nop 1
v_add_f32_dpp v3, v13, v3 quad_perm:[1,1,1,1] row_mask:0xf bank_mask:0xf
s_nop 1
v_add_f32_dpp v3, v14, v3 quad_perm:[2,2,2,2] row_mask:0xf bank_mask:0xf
s_nop 1
v_add_f32_dpp v3, v15, v3 quad_perm:[3,3,3,3] row_mask:0xf bank_mask:0xf
v_cvt_pk_bf16_f32 v3, v3, v3
v_and_b32 v54, 0xffff0000, v3
s_cbranch_scc1 AD_40
s_waitcnt vmcnt(2)
AD_40:
s_waitcnt vmcnt(3)
buffer_load_dwordx4 v[72:75], v2, s[12:15], s48 offen offset:0 nt
v_mov_b32_dpp v3, v16 quad_perm:[0,0,0,0] row_mask:0xf bank_mask:0xf
s_nop 1
v_add_f32_dpp v3, v17, v3 quad_perm:[1,1,1,1] row_mask:0xf bank_mask:0xf
s_nop 1
v_add_f32_dpp v3, v18, v3 quad_perm:[2,2,2,2] row_mask:0xf bank_mask:0xf
s_nop 1
v_add_f32_dpp v3, v19, v3 quad_perm:[3,3,3,3] row_mask:0xf bank_mask:0xf
v_cvt_pk_bf16_f32 v3, v3, v3
v_and_b32 v55, 0xffff0000, v3
v_max3_f32 v4, v40, v41, v42
v_max3_f32 v4, v4, v43, v44
v_max3_f32 v4, v4, v45, v46
v_max3_f32 v4, v4, v47, v48
v_max3_f32 v4, v4, v49, v50
v_max3_f32 v4, v4, v51, v52
v_max3_f32 v4, v4, v53, v54
v_max_f32 v4, v4, v55
v_mov_b32 v3, v4
s_nop 1
v_permlane32_swap_b32 v3, v4
v_max_f32 v4, v4, v3
v_mov_b32 v3, v4
s_nop 1
v_permlane16_swap_b32 v3, v4
v_max_f32 v4, v4, v3
v_sub_f32 v40, v40, v4
v_sub_f32 v41, v41, v4
v_sub_f32 v42, v42, v4
v_sub_f32 v43, v43, v4
v_sub_f32 v44, v44, v4
v_sub_f32 v45, v45, v4
v_sub_f32 v46, v46, v4
v_sub_f32 v47, v47, v4
v_sub_f32 v48, v48, v4
v_sub_f32 v49, v49, v4
v_sub_f32 v50, v50, v4
v_sub_f32 v51, v51, v4
v_sub_f32 v52, v52, v4
v_sub_f32 v53, v53, v4
v_sub_f32 v54, v54, v4
v_sub_f32 v55, v55, v4
v_mul_f32 v40, s27, v40
v_mul_f32 v41, s27, v41
v_mul_f32 v42, s27, v42
v_mul_f32 v43, s27, v43
v_mul_f32 v44, s27, v44
v_mul_f32 v45, s27, v45
v_mul_f32 v46, s27, v46
v_mul_f32 v47, s27, v47
v_mul_f32 v48, s27, v48
v_mul_f32 v49, s27, v49
v_mul_f32 v50, s27, v50
v_mul_f32 v51, s27, v51
v_mul_f32 v52, s27, v52
v_mul_f32 v53, s27, v53
v_mul_f32 v54, s27, v54
v_mul_f32 v55, s27, v55
v_exp_f32 v40, v40
v_exp_f32 v41, v41
v_exp_f32 v42, v42
v_exp_f32 v43, v43
v_exp_f32 v44, v44
v_exp_f32 v45, v45
v_exp_f32 v46, v46
v_exp_f32 v47, v47
v_exp_f32 v48, v48
v_exp_f32 v49, v49
v_exp_f32 v50, v50
v_exp_f32 v51, v51
v_exp_f32 v52, v52
v_exp_f32 v53, v53
v_exp_f32 v54, v54
v_exp_f32 v55, v55
v_add_f32 v5, v40, v41
v_add_f32 v6, v42, v43
v_add_f32 v5, v5, v44
v_add_f32 v6, v6, v45
v_add_f32 v5, v5, v46
v_add_f32 v6, v6, v47
v_add_f32 v5, v5, v48
v_add_f32 v6, v6, v49
v_add_f32 v5, v5, v50
v_add_f32 v6, v6, v51
v_add_f32 v5, v5, v52
v_add_f32 v6, v6, v53
v_add_f32 v5, v5, v54
v_add_f32 v6, v6, v55
v_add_f32 v5, v5, v6
s_lshl_b32 s28, s26, 4
v_add_u32 v6, s28, v0
v_mov_b32 v3, v5
s_nop 1
v_permlane32_swap_b32 v3, v5
v_add_f32 v5, v5, v3
v_mov_b32 v3, v5
s_nop 1
v_permlane16_swap_b32 v3, v5
v_add_f32 v5, v5, v3
s_mov_b64 exec, 0x101
ds_write_b64 v6, v[4:5] offset:24640
s_mov_b64 exec, -1
s_cmp_lg_u32 s31, 0
s_cbranch_scc1 AD_41
s_waitcnt vmcnt(2)
AD_41:
s_waitcnt vmcnt(3)
buffer_load_dwordx4 v[76:79], v2, s[12:15], s48 offen offset:256 nt
v_mbcnt_lo_u32_b32 v3, -1, 0
v_mbcnt_hi_u32_b32 v3, -1, v3
v_and_b32 v6, 1, v3
v_lshlrev_b32 v6, 4, v6
v_mov_b32 v7, 0xffff
v_lshlrev_b32 v6, v6, v7
v_bfe_u32 v7, v3, 1, 2
v_cmp_eq_u32 vcc, 0, v7
s_nop 1
v_cndmask_b32 v56, 0, v6, vcc
v_cmp_eq_u32 vcc, 1, v7
s_nop 1
v_cndmask_b32 v57, 0, v6, vcc
v_cmp_eq_u32 vcc, 2, v7
s_nop 1
v_cndmask_b32 v58, 0, v6, vcc
v_cmp_eq_u32 vcc, 3, v7
s_nop 1
v_cndmask_b32 v59, 0, v6, vcc
v_lshlrev_b32 v1, 4, v3
s_lshl_b32 s26, s26, 11
s_add_u32 s26, s26, 0
v_add_u32 v1, s26, v1
s_cmp_lg_u32 s31, 0
s_cbranch_scc1 AD_42
s_waitcnt vmcnt(2)
AD_42:
s_waitcnt vmcnt(3)
buffer_load_dwordx4 v[80:83], v2, s[12:15], s49 offen offset:0 nt
s_cbranch_scc1 AD_43
s_waitcnt vmcnt(2)
AD_43:
s_waitcnt vmcnt(3)
buffer_load_dwordx4 v[84:87], v2, s[12:15], s49 offen offset:256 nt
s_cbranch_scc1 AD_44
s_waitcnt vmcnt(2)
AD_44:
s_waitcnt vmcnt(3)
buffer_load_dwordx4 v[88:91], v2, s[12:15], s50 offen offset:0 nt
s_cbranch_scc1 AD_45
s_waitcnt vmcnt(2)
AD_45:
s_waitcnt vmcnt(3)
buffer_load_dwordx4 v[92:95], v2, s[12:15], s50 offen offset:256 nt
ds_read_b32 v3, v0 offset:24580
s_waitcnt lgkmcnt(0)
v_readfirstlane_b32 s30, v3
s_mov_b32 s31, s30
s_cmp_lg_u32 s31, 0
s_cbranch_scc1 AD_46
s_waitcnt vmcnt(2)
AD_46:
s_waitcnt vmcnt(5)
buffer_load_dwordx4 v[96:99], v2, s[12:15], s51 offen offset:0 nt
s_cbranch_scc1 AD_47
s_waitcnt vmcnt(2)
AD_47:
s_waitcnt vmcnt(5)
buffer_load_dwordx4 v[100:103], v2, s[12:15], s51 offen offset:256 nt
ds_read_b32 v3, v0 offset:24580
s_waitcnt lgkmcnt(0)
v_readfirstlane_b32 s30, v3
s_or_b32 s31, s31, s30
s_cmp_lg_u32 s31, 0
s_cbranch_scc1 AD_48
s_waitcnt vmcnt(2)
AD_48:
s_waitcnt vmcnt(5)
buffer_load_dwordx4 v[104:107], v2, s[12:15], s52 offen offset:0 nt
s_cbranch_scc1 AD_49
s_waitcnt vmcnt(2)
AD_49:
s_waitcnt vmcnt(5)
buffer_load_dwordx4 v[108:111], v2, s[12:15], s52 offen offset:256 nt
ds_read_b32 v3, v0 offset:24580
s_waitcnt lgkmcnt(0)
v_readfirstlane_b32 s30, v3
s_or_b32 s31, s31, s30
s_cmp_lg_u32 s31, 0
s_cbranch_scc1 AD_50
s_waitcnt vmcnt(2)
AD_50:
s_waitcnt vmcnt(5)
buffer_load_dwordx4 v[112:115], v2, s[12:15], s53 offen offset:0 nt
s_cbranch_scc1 AD_51
s_waitcnt vmcnt(2)
AD_51:
s_waitcnt vmcnt(5)
buffer_load_dwordx4 v[116:119], v2, s[12:15], s53 offen offset:256 nt
s_cbranch_scc1 AD_52
s_waitcnt vmcnt(2)
AD_52:
s_waitcnt vmcnt(5)
buffer_load_dwordx4 v[120:123], v2, s[12:15], s54 offen offset:0 nt
s_mov_b32 s29, 2560000
SW_53:
ds_read_b64 v[6:7], v0 offset:24576
s_waitcnt lgkmcnt(0)
v_cmp_eq_u32 vcc, 0, v7
s_cbranch_vccz SWD_54
s_sub_u32 s29, s29, 1
s_cbranch_scc0 SW_53
SWD_54:
s_cmp_eq_u32 s29, 2560000
v_sub_f32 v4, v4, v6
v_mul_f32 v4, s27, v4
v_exp_f32 v4, v4
s_nop 0
v_mul_f32 v4, v4, v7
v_mul_f32 v40, v40, v4
v_mul_f32 v41, v41, v4
v_mul_f32 v42, v42, v4
v_mul_f32 v43, v43, v4
v_mul_f32 v44, v44, v4
v_mul_f32 v45, v45, v4
v_mul_f32 v46, v46, v4
v_mul_f32 v47, v47, v4
v_mul_f32 v48, v48, v4
v_mul_f32 v49, v49, v4
v_mul_f32 v50, v50, v4
v_mul_f32 v51, v51, v4
v_mul_f32 v52, v52, v4
v_mul_f32 v53, v53, v4
v_mul_f32 v54, v54, v4
v_mul_f32 v55, v55, v4
v_cvt_pk_bf16_f32 v40, v40, v40
v_cvt_pk_bf16_f32 v41, v41, v41
v_cvt_pk_bf16_f32 v42, v42, v42
v_cvt_pk_bf16_f32 v43, v43, v43
v_cvt_pk_bf16_f32 v44, v44, v44
v_cvt_pk_bf16_f32 v45, v45, v45
v_cvt_pk_bf16_f32 v46, v46, v46
v_cvt_pk_bf16_f32 v47, v47, v47
v_cvt_pk_bf16_f32 v48, v48, v48
v_cvt_pk_bf16_f32 v49, v49, v49
v_cvt_pk_bf16_f32 v50, v50, v50
v_cvt_pk_bf16_f32 v51, v51, v51
v_cvt_pk_bf16_f32 v52, v52, v52
v_cvt_pk_bf16_f32 v53, v53, v53
v_cvt_pk_bf16_f32 v54, v54, v54
v_cvt_pk_bf16_f32 v55, v55, v55
v_and_b32 v12, v40, v56
v_and_b32 v13, v40, v57
v_and_b32 v14, v40, v58
v_and_b32 v15, v40, v59
s_cbranch_scc1 AD_55
s_waitcnt vmcnt(2)
AD_55:
s_waitcnt vmcnt(7)
buffer_load_dwordx4 v[124:127], v2, s[12:15], s54 offen offset:256 nt
v_and_b32 v16, v41, v56
v_and_b32 v17, v41, v57
v_and_b32 v18, v41, v58
v_and_b32 v19, v41, v59
v_mfma_f32_16x16x32_bf16 v[4:7], v[20:23], v[12:15], 0
v_mfma_f32_16x16x32_bf16 v[8:11], v[24:27], v[12:15], 0
v_and_b32 v12, v42, v56
v_and_b32 v13, v42, v57
v_and_b32 v14, v42, v58
v_and_b32 v15, v42, v59
v_mfma_f32_16x16x32_bf16 v[4:7], v[28:31], v[16:19], v[4:7]
v_mfma_f32_16x16x32_bf16 v[8:11], v[32:35], v[16:19], v[8:11]
s_cbranch_scc1 AD_56
s_waitcnt vmcnt(2)
AD_56:
s_waitcnt vmcnt(7)
buffer_load_dwordx4 v[128:131], v2, s[12:15], s55 offen offset:0 nt
v_and_b32 v16, v43, v56
v_and_b32 v17, v43, v57
v_and_b32 v18, v43, v58
v_and_b32 v19, v43, v59
v_mfma_f32_16x16x32_bf16 v[4:7], v[36:39], v[12:15], v[4:7]
v_mfma_f32_16x16x32_bf16 v[8:11], v[60:63], v[12:15], v[8:11]
v_and_b32 v12, v44, v56
v_and_b32 v13, v44, v57
v_and_b32 v14, v44, v58
v_and_b32 v15, v44, v59
v_mfma_f32_16x16x32_bf16 v[4:7], v[64:67], v[16:19], v[4:7]
v_mfma_f32_16x16x32_bf16 v[8:11], v[68:71], v[16:19], v[8:11]
s_cbranch_scc1 AD_57
s_waitcnt vmcnt(2)
AD_57:
s_waitcnt vmcnt(7)
buffer_load_dwordx4 v[132:135], v2, s[12:15], s55 offen offset:256 nt
v_and_b32 v16, v45, v56
v_and_b32 v17, v45, v57
v_and_b32 v18, v45, v58
v_and_b32 v19, v45, v59
v_mfma_f32_16x16x32_bf16 v[4:7], v[72:75], v[12:15], v[4:7]
v_mfma_f32_16x16x32_bf16 v[8:11], v[76:79], v[12:15], v[8:11]
v_and_b32 v12, v46, v56
v_and_b32 v13, v46, v57
v_and_b32 v14, v46, v58
v_and_b32 v15, v46, v59
v_mfma_f32_16x16x32_bf16 v[4:7], v[80:83], v[16:19], v[4:7]
v_mfma_f32_16x16x32_bf16 v[8:11], v[84:87], v[16:19], v[8:11]
s_cbranch_scc1 AD_58
s_waitcnt vmcnt(2)
AD_58:
s_waitcnt vmcnt(7)
buffer_load_dwordx4 v[136:139], v2, s[12:15], s56 offen offset:0 nt
v_and_b32 v16, v47, v56
v_and_b32 v17, v47, v57
v_and_b32 v18, v47, v58
v_and_b32 v19, v47, v59
v_mfma_f32_16x16x32_bf16 v[4:7], v[88:91], v[12:15], v[4:7]
v_mfma_f32_16x16x32_bf16 v[8:11], v[92:95], v[12:15], v[8:11]
v_and_b32 v12, v48, v56
v_and_b32 v13, v48, v57
v_and_b32 v14, v48, v58
v_and_b32 v15, v48, v59
v_mfma_f32_16x16x32_bf16 v[4:7], v[96:99], v[16:19], v[4:7]
v_mfma_f32_16x16x32_bf16 v[8:11], v[100:103], v[16:19], v[8:11]
s_cbranch_scc1 AD_59
s_waitcnt vmcnt(2)
AD_59:
s_waitcnt vmcnt(7)
buffer_load_dwordx4 v[140:143], v2, s[12:15], s56 offen offset:256 nt
v_and_b32 v16, v49, v56
v_and_b32 v17, v49, v57
v_and_b32 v18, v49, v58
v_and_b32 v19, v49, v59
v_mfma_f32_16x16x32_bf16 v[4:7], v[104:107], v[12:15], v[4:7]
v_mfma_f32_16x16x32_bf16 v[8:11], v[108:111], v[12:15], v[8:11]
s_cbranch_scc1 AD_60
s_waitcnt vmcnt(2)
AD_60:
s_waitcnt vmcnt(7)
buffer_load_dwordx4 v[144:147], v2, s[12:15], s57 offen offset:0 nt
v_and_b32 v12, v50, v56
v_and_b32 v13, v50, v57
v_and_b32 v14, v50, v58
v_and_b32 v15, v50, v59
v_mfma_f32_16x16x32_bf16 v[4:7], v[112:115], v[16:19], v[4:7]
s_cbranch_scc1 AD_61
s_waitcnt vmcnt(2)
AD_61:
s_waitcnt vmcnt(7)
buffer_load_dwordx4 v[148:151], v2, s[12:15], s57 offen offset:256 nt
v_mfma_f32_16x16x32_bf16 v[8:11], v[116:119], v[16:19], v[8:11]
s_cbranch_scc1 AD_62
s_waitcnt vmcnt(2)
AD_62:
s_waitcnt vmcnt(7)
buffer_load_dwordx4 v[152:155], v2, s[12:15], s58 offen offset:0 nt
v_and_b32 v16, v51, v56
v_and_b32 v17, v51, v57
v_and_b32 v18, v51, v58
v_and_b32 v19, v51, v59
v_mfma_f32_16x16x32_bf16 v[4:7], v[120:123], v[12:15], v[4:7]
s_cbranch_scc1 AD_63
s_waitcnt vmcnt(2)
AD_63:
s_waitcnt vmcnt(7)
buffer_load_dwordx4 v[156:159], v2, s[12:15], s58 offen offset:256 nt
v_mfma_f32_16x16x32_bf16 v[8:11], v[124:127], v[12:15], v[8:11]
s_cbranch_scc1 AD_64
s_waitcnt vmcnt(2)
AD_64:
s_waitcnt vmcnt(7)
buffer_load_dwordx4 v[160:163], v2, s[12:15], s59 offen offset:0 nt
v_and_b32 v12, v52, v56
v_and_b32 v13, v52, v57
v_and_b32 v14, v52, v58
v_and_b32 v15, v52, v59
v_mfma_f32_16x16x32_bf16 v[4:7], v[128:131], v[16:19], v[4:7]
s_cbranch_scc1 AD_65
s_waitcnt vmcnt(2)
AD_65:
s_waitcnt vmcnt(7)
buffer_load_dwordx4 v[164:167], v2, s[12:15], s59 offen offset:256 nt
v_mfma_f32_16x16x32_bf16 v[8:11], v[132:135], v[16:19], v[8:11]
s_waitcnt vmcnt(7)
v_and_b32 v16, v53, v56
v_and_b32 v17, v53, v57
v_and_b32 v18, v53, v58
v_and_b32 v19, v53, v59
v_mfma_f32_16x16x32_bf16 v[4:7], v[136:139], v[12:15], v[4:7]
s_waitcnt vmcnt(6)
v_mfma_f32_16x16x32_bf16 v[8:11], v[140:143], v[12:15], v[8:11]
s_waitcnt vmcnt(5)
v_and_b32 v12, v54, v56
v_and_b32 v13, v54, v57
v_and_b32 v14, v54, v58
v_and_b32 v15, v54, v59
v_mfma_f32_16x16x32_bf16 v[4:7], v[144:147], v[16:19], v[4:7]
s_waitcnt vmcnt(4)
v_mfma_f32_16x16x32_bf16 v[8:11], v[148:151], v[16:19], v[8:11]
s_waitcnt vmcnt(3)
v_and_b32 v16, v55, v56
v_and_b32 v17, v55, v57
v_and_b32 v18, v55, v58
v_and_b32 v19, v55, v59
v_mfma_f32_16x16x32_bf16 v[4:7], v[152:155], v[12:15], v[4:7]
s_waitcnt vmcnt(2)
v_mfma_f32_16x16x32_bf16 v[8:11], v[156:159], v[12:15], v[8:11]
s_waitcnt vmcnt(1)
v_mfma_f32_16x16x32_bf16 v[4:7], v[160:163], v[16:19], v[4:7]
s_waitcnt vmcnt(0)
v_mfma_f32_16x16x32_bf16 v[8:11], v[164:167], v[16:19], v[8:11]
s_nop 5
ds_write_b128 v1, v[4:7]
s_nop 0
ds_write_b128 v1, v[8:11] offset:1024
s_waitcnt lgkmcnt(0)
s_barrier
s_endpgm
L_HELP:
s_setprio 3
s_load_dwordx2 s[26:27], s[0:1], 96
s_load_dwordx4 s[36:39], s[0:1], 64
s_load_dwordx4 s[28:31], s[0:1], 24
s_load_dwordx2 s[24:25], s[0:1], 0
s_load_dwordx4 s[32:35], s[0:1], 48
s_load_dwordx4 s[40:43], s[0:1], 80
s_lshr_b32 s8, s2, 3
s_and_b32 s9, s2, 7
s_lshr_b32 s10, s8, 3
s_and_b32 s11, s8, 7
s_mov_b32 s14, 0xfffffc00
s_movk_i32 s15, 0x3ff
s_mov_b32 s81, 0xffff0000
s_mov_b32 s82, 0x07060302
s_lshl_b32 s80, s3, 14
s_add_u32 s80, s80, 86272
v_and_b32 v14, 15, v0
v_lshrrev_b32 v15, 4, v0
v_mov_b32 v12, 0
v_lshlrev_b32 v11, 2, v0
ds_write_b32 v11, v12 offset:24576
v_mov_b32 v16, 0
v_mov_b32 v17, 0
v_mov_b32 v18, 0
v_mov_b32 v19, 0
v_lshlrev_b32 v13, 4, v0
s_mul_i32 s21, s3, 896
s_getreg_b32 s18, hwreg(HW_REG_XCC_ID, 0, 4)
s_add_u32 s18, s18, 1
v_mov_b32 v47, s18
s_lshl_b32 s19, s11, 5
v_lshl_add_u32 v46, v0, 2, s19
s_lshl_b32 s17, s10, 3
s_add_u32 s17, s17, s9
s_add_u32 s17, s17, s19
v_mov_b32 v45, s17
s_cmp_eq_u32 s3, 2
s_waitcnt lgkmcnt(0)
s_cbranch_scc0 L_XW
s_mov_b64 exec, 1
global_store_byte v45, v47, s[42:43]
s_mov_b64 exec, -1
L_XW:
s_mov_b32 s76, s26
s_mov_b32 s77, s27
s_mov_b32 s78, 0x10000000
s_mov_b32 s79, 0x20000
buffer_load_dword v1, v12, s[76:79], 0 offen sc1
s_mov_b32 s44, s24
s_mov_b32 s45, s25
s_mov_b32 s46, 0xe00
s_mov_b32 s47, 0x20000
s_mov_b32 s48, s28
s_mov_b32 s49, s29
s_mov_b32 s50, 0x380000
s_mov_b32 s51, 0x20000
s_mov_b32 s52, s30
s_mov_b32 s53, s31
s_mov_b32 s54, 0x380000
s_mov_b32 s55, 0x20000
s_mov_b32 s56, s32
s_mov_b32 s57, s33
s_mov_b32 s58, 0x188000
s_mov_b32 s59, 0x20000
s_mov_b32 s60, s34
s_mov_b32 s61, s35
s_mov_b32 s62, 0x188000
s_mov_b32 s63, 0x20000
s_mov_b32 s64, s36
s_mov_b32 s65, s37
s_mov_b32 s66, 0xe00
s_mov_b32 s67, 0x20000
s_mov_b32 s68, s38
s_mov_b32 s69, s39
s_mov_b32 s70, 0x24c000
s_mov_b32 s71, 0x20000
s_mov_b32 s72, s40
s_mov_b32 s73, s41
s_mov_b32 s74, 0xe00
s_mov_b32 s75, 0x20000
s_mov_b32 s4, s84
s_mov_b32 s5, s85
s_sub_u32 s6, s9, 1
s_lshl_b32 s7, s11, 2
s_add_u32 s7, s7, s10
s_mul_i32 s12, s11, 7
s_add_u32 s12, s12, s6
s_cmp_eq_u32 s4, 0
s_cbranch_scc0 L_NOTF
s_mov_b32 exec_lo, -1
s_mov_b32 exec_hi, 0x00ffffff
buffer_load_dwordx4 v[16:19], v13, s[44:47], s21 offen nt
s_mov_b64 exec, -1
v_lshlrev_b32 v10, 4, v14
v_lshlrev_b32 v11, 5, v15
v_xor_b32 v10, v10, v11
v_lshl_add_u32 v10, v15, 13, v10
v_xor_b32 v11, 0x80, v10
s_mul_i32 s20, s3, 917504
s_lshl_b32 s22, s7, 8
s_add_u32 s20, s20, s22
s_mul_i32 s22, s3, 28672
s_add_u32 s22, s22, 28928
s_add_u32 m0, s22, 0
s_add_u32 s17, s20, 0
buffer_load_dwordx4 v10, s[48:51], s17 offen nt lds
s_add_u32 m0, s22, 1024
s_add_u32 s17, s20, 32768
buffer_load_dwordx4 v10, s[48:51], s17 offen nt lds
s_add_u32 m0, s22, 2048
s_add_u32 s17, s20, 65536
buffer_load_dwordx4 v11, s[48:51], s17 offen nt lds
s_add_u32 m0, s22, 3072
s_add_u32 s17, s20, 98304
buffer_load_dwordx4 v11, s[48:51], s17 offen nt lds
s_add_u32 m0, s22, 4096
s_add_u32 s17, s20, 131072
buffer_load_dwordx4 v10, s[48:51], s17 offen nt lds
s_add_u32 m0, s22, 5120
s_add_u32 s17, s20, 163840
buffer_load_dwordx4 v10, s[48:51], s17 offen nt lds
s_add_u32 m0, s22, 6144
s_add_u32 s17, s20, 196608
buffer_load_dwordx4 v11, s[48:51], s17 offen nt lds
s_add_u32 m0, s22, 7168
s_add_u32 s17, s20, 229376
buffer_load_dwordx4 v11, s[48:51], s17 offen nt lds
s_add_u32 m0, s22, 8192
s_add_u32 s17, s20, 262144
buffer_load_dwordx4 v10, s[48:51], s17 offen nt lds
s_add_u32 m0, s22, 9216
s_add_u32 s17, s20, 294912
buffer_load_dwordx4 v10, s[48:51], s17 offen nt lds
s_add_u32 m0, s22, 10240
s_add_u32 s17, s20, 327680
buffer_load_dwordx4 v11, s[48:51], s17 offen nt lds
s_add_u32 m0, s22, 11264
s_add_u32 s17, s20, 360448
buffer_load_dwordx4 v11, s[48:51], s17 offen nt lds
s_add_u32 m0, s22, 12288
s_add_u32 s17, s20, 393216
buffer_load_dwordx4 v10, s[48:51], s17 offen nt lds
s_add_u32 m0, s22, 13312
s_add_u32 s17, s20, 425984
buffer_load_dwordx4 v10, s[48:51], s17 offen nt lds
s_add_u32 m0, s22, 14336
s_add_u32 s17, s20, 458752
buffer_load_dwordx4 v11, s[48:51], s17 offen nt lds
s_add_u32 m0, s22, 15360
s_add_u32 s17, s20, 491520
buffer_load_dwordx4 v11, s[48:51], s17 offen nt lds
s_add_u32 m0, s22, 16384
s_add_u32 s17, s20, 524288
buffer_load_dwordx4 v10, s[48:51], s17 offen nt lds
s_add_u32 m0, s22, 17408
s_add_u32 s17, s20, 557056
buffer_load_dwordx4 v10, s[48:51], s17 offen nt lds
s_add_u32 m0, s22, 18432
s_add_u32 s17, s20, 589824
buffer_load_dwordx4 v11, s[48:51], s17 offen nt lds
s_add_u32 m0, s22, 19456
s_add_u32 s17, s20, 622592
buffer_load_dwordx4 v11, s[48:51], s17 offen nt lds
s_add_u32 m0, s22, 20480
s_add_u32 s17, s20, 655360
buffer_load_dwordx4 v10, s[48:51], s17 offen nt lds
s_add_u32 m0, s22, 21504
s_add_u32 s17, s20, 688128
buffer_load_dwordx4 v10, s[48:51], s17 offen nt lds
s_add_u32 m0, s22, 22528
s_add_u32 s17, s20, 720896
buffer_load_dwordx4 v11, s[48:51], s17 offen nt lds
s_add_u32 m0, s22, 23552
s_add_u32 s17, s20, 753664
buffer_load_dwordx4 v11, s[48:51], s17 offen nt lds
s_add_u32 m0, s22, 24576
s_add_u32 s17, s20, 786432
buffer_load_dwordx4 v10, s[48:51], s17 offen nt lds
s_add_u32 m0, s22, 25600
s_add_u32 s17, s20, 819200
buffer_load_dwordx4 v10, s[48:51], s17 offen nt lds
s_add_u32 m0, s22, 26624
s_add_u32 s17, s20, 851968
buffer_load_dwordx4 v11, s[48:51], s17 offen nt lds
s_add_u32 m0, s22, 27648
s_add_u32 s17, s20, 884736
buffer_load_dwordx4 v11, s[48:51], s17 offen nt lds
s_barrier
s_waitcnt vmcnt(28)
v_readfirstlane_b32 s13, v1
s_add_u32 s13, s13, 1
s_and_b32 s17, s13, 0xffff
v_mov_b32 v1, s17
v_lshlrev_b32 v20, 16, v16
v_and_b32 v21, s81, v16
v_lshlrev_b32 v22, 16, v17
v_and_b32 v23, s81, v17
v_lshlrev_b32 v24, 16, v18
v_and_b32 v25, s81, v18
v_lshlrev_b32 v26, 16, v19
v_and_b32 v27, s81, v19
v_add_f32 v2, v20, v21
v_add_f32 v3, v22, v23
v_add_f32 v4, v24, v25
v_add_f32 v5, v26, v27
v_add_f32 v2, v2, v3
v_add_f32 v4, v4, v5
v_add_f32 v2, v2, v4
s_nop 1
v_add_f32_dpp v2, v2, v2 quad_perm:[1,0,3,2] row_mask:0xf bank_mask:0xf
s_nop 1
v_add_f32_dpp v2, v2, v2 quad_perm:[2,3,0,1] row_mask:0xf bank_mask:0xf
s_nop 1
v_add_f32_dpp v2, v2, v2 row_half_mirror row_mask:0xf bank_mask:0xf
s_nop 1
v_add_f32_dpp v2, v2, v2 row_mirror row_mask:0xf bank_mask:0xf
v_mov_b32 v4, v2
s_nop 1
v_permlane32_swap_b32 v4, v2
v_add_f32 v2, v2, v4
v_mov_b32 v4, v2
s_nop 1
v_permlane16_swap_b32 v4, v2
v_add_f32 v2, v2, v4
v_mul_f32 v2, 0x3b124925, v2
v_mov_b32 v3, 0
s_mov_b32 exec_lo, -1
s_mov_b32 exec_hi, 0x00ffffff
v_sub_f32 v4, v20, v2
v_fmac_f32 v3, v4, v4
v_sub_f32 v4, v21, v2
v_fmac_f32 v3, v4, v4
v_sub_f32 v4, v22, v2
v_fmac_f32 v3, v4, v4
v_sub_f32 v4, v23, v2
v_fmac_f32 v3, v4, v4
v_sub_f32 v4, v24, v2
v_fmac_f32 v3, v4, v4
v_sub_f32 v4, v25, v2
v_fmac_f32 v3, v4, v4
v_sub_f32 v4, v26, v2
v_fmac_f32 v3, v4, v4
v_sub_f32 v4, v27, v2
v_fmac_f32 v3, v4, v4
s_mov_b64 exec, -1
s_nop 0
v_add_f32_dpp v3, v3, v3 quad_perm:[1,0,3,2] row_mask:0xf bank_mask:0xf
s_nop 1
v_add_f32_dpp v3, v3, v3 quad_perm:[2,3,0,1] row_mask:0xf bank_mask:0xf
s_nop 1
v_add_f32_dpp v3, v3, v3 row_half_mirror row_mask:0xf bank_mask:0xf
s_nop 1
v_add_f32_dpp v3, v3, v3 row_mirror row_mask:0xf bank_mask:0xf
v_mov_b32 v4, v3
s_nop 1
v_permlane32_swap_b32 v4, v3
v_add_f32 v3, v3, v4
v_mov_b32 v4, v3
s_nop 1
v_permlane16_swap_b32 v4, v3
v_add_f32 v3, v3, v4
v_mul_f32 v3, 0x3b124925, v3
v_cvt_pk_bf16_f32 v3, v2, v3
v_lshlrev_b32 v2, 16, v3
v_and_b32 v3, s81, v3
v_add_f32 v3, 0x3727c5ac, v3
v_cvt_pk_bf16_f32 v3, v3, v3
v_and_b32 v3, s81, v3
v_sqrt_f32 v3, v3
s_nop 0
v_cvt_pk_bf16_f32 v3, v3, v3
v_and_b32 v3, s81, v3
v_rcp_f32 v3, v3
v_sub_f32 v20, v20, v2
v_sub_f32 v21, v21, v2
v_sub_f32 v22, v22, v2
v_sub_f32 v23, v23, v2
v_sub_f32 v24, v24, v2
v_sub_f32 v25, v25, v2
v_sub_f32 v26, v26, v2
v_sub_f32 v27, v27, v2
v_cvt_pk_bf16_f32 v4, v20, v21
v_lshlrev_b32 v20, 16, v4
v_and_b32 v21, s81, v4
v_cvt_pk_bf16_f32 v5, v22, v23
v_lshlrev_b32 v22, 16, v5
v_and_b32 v23, s81, v5
v_cvt_pk_bf16_f32 v6, v24, v25
v_lshlrev_b32 v24, 16, v6
v_and_b32 v25, s81, v6
v_cvt_pk_bf16_f32 v7, v26, v27
v_lshlrev_b32 v26, 16, v7
v_and_b32 v27, s81, v7
v_mul_f32 v20, v20, v3
v_mul_f32 v21, v21, v3
v_mul_f32 v22, v22, v3
v_mul_f32 v23, v23, v3
v_mul_f32 v24, v24, v3
v_mul_f32 v25, v25, v3
v_mul_f32 v26, v26, v3
v_mul_f32 v27, v27, v3
v_cvt_pk_bf16_f32 v4, v20, v21
v_lshlrev_b32 v20, 16, v4
v_and_b32 v21, s81, v4
v_cvt_pk_bf16_f32 v5, v22, v23
v_lshlrev_b32 v22, 16, v5
v_and_b32 v23, s81, v5
v_cvt_pk_bf16_f32 v6, v24, v25
v_lshlrev_b32 v24, 16, v6
v_and_b32 v25, s81, v6
v_cvt_pk_bf16_f32 v7, v26, v27
v_lshlrev_b32 v26, 16, v7
v_and_b32 v27, s81, v7
v_lshrrev_b32 v4, 2, v14
v_and_b32 v5, 1, v15
v_lshl_or_b32 v5, v5, 2, v4
s_lshl_b32 s17, s3, 1
v_xor_b32 v5, s17, v5
v_lshlrev_b32 v5, 5, v5
v_lshl_add_u32 v4, v15, 3, v4
v_lshl_add_u32 v5, v4, 8, v5
v_and_b32 v4, 3, v14
v_lshl_add_u32 v5, v4, 3, v5
v_add_u32 v8, 28928, v5
v_xor_b32 v9, 32, v8
v_lshlrev_b32 v12, 5, v0
s_mul_i32 s20, s3, 10752
s_add_u32 s20, s20, 16384
s_waitcnt vmcnt(0)
s_mov_b64 exec, 0xff
global_load_dword v45, v46, s[42:43] sc1
s_mov_b64 exec, -1
v_mov_b32 v2, 24608
v_mov_b32 v3, 1
s_mov_b64 exec, 1
ds_add_u32 v2, v3
s_mov_b64 exec, -1
v_mov_b32 v2, 24608
s_mov_b32 s16, 2560000
SW_66:
ds_read_b32 v3, v2
s_waitcnt lgkmcnt(0)
v_cmp_gt_u32 vcc, 4, v3
s_cbranch_vccz SWD_67
s_sub_u32 s16, s16, 1
s_cbranch_scc0 SW_66
SWD_67:
ds_read_b64_tr_b16 v[48:49], v8 offset:0
ds_read_b64_tr_b16 v[50:51], v8 offset:1024
ds_read_b64_tr_b16 v[104:105], v9 offset:0
ds_read_b64_tr_b16 v[106:107], v9 offset:1024
ds_read_b64_tr_b16 v[52:53], v8 offset:8192
ds_read_b64_tr_b16 v[54:55], v8 offset:9216
ds_read_b64_tr_b16 v[108:109], v9 offset:8192
ds_read_b64_tr_b16 v[110:111], v9 offset:9216
ds_read_b64_tr_b16 v[56:57], v8 offset:16384
ds_read_b64_tr_b16 v[58:59], v8 offset:17408
ds_read_b64_tr_b16 v[112:113], v9 offset:16384
ds_read_b64_tr_b16 v[114:115], v9 offset:17408
ds_read_b64_tr_b16 v[60:61], v8 offset:24576
ds_read_b64_tr_b16 v[62:63], v8 offset:25600
ds_read_b64_tr_b16 v[116:117], v9 offset:24576
ds_read_b64_tr_b16 v[118:119], v9 offset:25600
ds_read_b64_tr_b16 v[64:65], v8 offset:32768
ds_read_b64_tr_b16 v[66:67], v8 offset:33792
ds_read_b64_tr_b16 v[120:121], v9 offset:32768
ds_read_b64_tr_b16 v[122:123], v9 offset:33792
ds_read_b64_tr_b16 v[68:69], v8 offset:40960
ds_read_b64_tr_b16 v[70:71], v8 offset:41984
ds_read_b64_tr_b16 v[124:125], v9 offset:40960
ds_read_b64_tr_b16 v[126:127], v9 offset:41984
ds_read_b64_tr_b16 v[72:73], v8 offset:49152
ds_read_b64_tr_b16 v[74:75], v8 offset:50176
ds_read_b64_tr_b16 v[128:129], v9 offset:49152
ds_read_b64_tr_b16 v[130:131], v9 offset:50176
v_add_u32 v8, 57344, v8
v_add_u32 v9, 57344, v9
ds_read_b64_tr_b16 v[76:77], v8 offset:0
ds_read_b64_tr_b16 v[78:79], v8 offset:1024
ds_read_b64_tr_b16 v[132:133], v9 offset:0
ds_read_b64_tr_b16 v[134:135], v9 offset:1024
ds_read_b64_tr_b16 v[80:81], v8 offset:8192
ds_read_b64_tr_b16 v[82:83], v8 offset:9216
ds_read_b64_tr_b16 v[136:137], v9 offset:8192
ds_read_b64_tr_b16 v[138:139], v9 offset:9216
ds_read_b64_tr_b16 v[84:85], v8 offset:16384
ds_read_b64_tr_b16 v[86:87], v8 offset:17408
ds_read_b64_tr_b16 v[140:141], v9 offset:16384
ds_read_b64_tr_b16 v[142:143], v9 offset:17408
ds_read_b64_tr_b16 v[88:89], v8 offset:24576
ds_read_b64_tr_b16 v[90:91], v8 offset:25600
ds_read_b64_tr_b16 v[144:145], v9 offset:24576
ds_read_b64_tr_b16 v[146:147], v9 offset:25600
ds_read_b64_tr_b16 v[92:93], v8 offset:32768
ds_read_b64_tr_b16 v[94:95], v8 offset:33792
ds_read_b64_tr_b16 v[148:149], v9 offset:32768
ds_read_b64_tr_b16 v[150:151], v9 offset:33792
ds_read_b64_tr_b16 v[96:97], v8 offset:40960
ds_read_b64_tr_b16 v[98:99], v8 offset:41984
ds_read_b64_tr_b16 v[152:153], v9 offset:40960
ds_read_b64_tr_b16 v[154:155], v9 offset:41984
ds_read_b64_tr_b16 v[100:101], v8 offset:49152
ds_read_b64_tr_b16 v[102:103], v8 offset:50176
ds_read_b64_tr_b16 v[156:157], v9 offset:49152
ds_read_b64_tr_b16 v[158:159], v9 offset:50176
s_mov_b32 exec_lo, -1
s_mov_b32 exec_hi, 0x00ffffff
s_mov_b32 s16, 40000
s_mov_b64 s[0:1], exec
PL_68:
buffer_load_dwordx4 v[28:31], v12, s[76:79], s20 offen offset:0 sc1
buffer_load_dwordx4 v[32:35], v12, s[76:79], s20 offen offset:16 sc1
buffer_load_dwordx4 v[36:39], v12, s[76:79], s20 offen offset:1792 sc1
buffer_load_dwordx4 v[40:43], v12, s[76:79], s20 offen offset:1808 sc1
s_waitcnt vmcnt(0)
v_bitop3_b32 v44, v28, v29, v1 bitop3:0x7e
v_bitop3_b32 v44, v44, v30, v1 bitop3:0xf6
v_bitop3_b32 v44, v44, v31, v1 bitop3:0xf6
v_bitop3_b32 v44, v44, v32, v1 bitop3:0xf6
v_bitop3_b32 v44, v44, v33, v1 bitop3:0xf6
v_bitop3_b32 v44, v44, v34, v1 bitop3:0xf6
v_bitop3_b32 v44, v44, v35, v1 bitop3:0xf6
v_bitop3_b32 v44, v44, v36, v1 bitop3:0xf6
v_bitop3_b32 v44, v44, v37, v1 bitop3:0xf6
v_bitop3_b32 v44, v44, v38, v1 bitop3:0xf6
v_bitop3_b32 v44, v44, v39, v1 bitop3:0xf6
v_bitop3_b32 v44, v44, v40, v1 bitop3:0xf6
v_bitop3_b32 v44, v44, v41, v1 bitop3:0xf6
v_bitop3_b32 v44, v44, v42, v1 bitop3:0xf6
v_bitop3_b32 v44, v44, v43, v1 bitop3:0xf6
v_and_b32 v44, 0xffff, v44
v_cmp_ne_u32 vcc, 0, v44
s_cbranch_vccz PD_69
s_mov_b64 exec, vcc
s_sub_u32 s16, s16, 1
s_cbranch_scc0 PL_68
PD_69:
s_mov_b64 exec, s[0:1]
v_and_b32 v36, s81, v36
v_add_f32 v36, 1.0, v36
v_and_b32 v37, s81, v37
v_add_f32 v37, 1.0, v37
v_and_b32 v38, s81, v38
v_add_f32 v38, 1.0, v38
v_and_b32 v39, s81, v39
v_add_f32 v39, 1.0, v39
v_and_b32 v40, s81, v40
v_add_f32 v40, 1.0, v40
v_and_b32 v41, s81, v41
v_add_f32 v41, 1.0, v41
v_and_b32 v42, s81, v42
v_add_f32 v42, 1.0, v42
v_and_b32 v43, s81, v43
v_add_f32 v43, 1.0, v43
v_cvt_pk_bf16_f32 v4, v36, v37
v_lshlrev_b32 v36, 16, v4
v_and_b32 v37, s81, v4
v_cvt_pk_bf16_f32 v5, v38, v39
v_lshlrev_b32 v38, 16, v5
v_and_b32 v39, s81, v5
v_cvt_pk_bf16_f32 v6, v40, v41
v_lshlrev_b32 v40, 16, v6
v_and_b32 v41, s81, v6
v_cvt_pk_bf16_f32 v7, v42, v43
v_lshlrev_b32 v42, 16, v7
v_and_b32 v43, s81, v7
v_mul_f32 v20, v20, v36
v_mul_f32 v21, v21, v37
v_mul_f32 v22, v22, v38
v_mul_f32 v23, v23, v39
v_mul_f32 v24, v24, v40
v_mul_f32 v25, v25, v41
v_mul_f32 v26, v26, v42
v_mul_f32 v27, v27, v43
v_cvt_pk_bf16_f32 v4, v20, v21
v_lshlrev_b32 v20, 16, v4
v_and_b32 v21, s81, v4
v_cvt_pk_bf16_f32 v5, v22, v23
v_lshlrev_b32 v22, 16, v5
v_and_b32 v23, s81, v5
v_cvt_pk_bf16_f32 v6, v24, v25
v_lshlrev_b32 v24, 16, v6
v_and_b32 v25, s81, v6
v_cvt_pk_bf16_f32 v7, v26, v27
v_lshlrev_b32 v26, 16, v7
v_and_b32 v27, s81, v7
v_and_b32 v28, s81, v28
v_add_f32 v20, v20, v28
v_and_b32 v29, s81, v29
v_add_f32 v21, v21, v29
v_and_b32 v30, s81, v30
v_add_f32 v22, v22, v30
v_and_b32 v31, s81, v31
v_add_f32 v23, v23, v31
v_and_b32 v32, s81, v32
v_add_f32 v24, v24, v32
v_and_b32 v33, s81, v33
v_add_f32 v25, v25, v33
v_and_b32 v34, s81, v34
v_add_f32 v26, v26, v34
v_and_b32 v35, s81, v35
v_add_f32 v27, v27, v35
v_cvt_pk_bf16_f32 v16, v20, v21
v_cvt_pk_bf16_f32 v17, v22, v23
v_cvt_pk_bf16_f32 v18, v24, v25
v_cvt_pk_bf16_f32 v19, v26, v27
v_add_u32 v13, s21, v13
ds_write_b128 v13, v[16:19] offset:19968
s_mov_b64 exec, -1
s_getreg_b32 s37, hwreg(HW_REG_XCC_ID, 0, 4)
s_add_u32 s37, s37, 1
s_mul_i32 s37, s37, 0x01010101
s_mov_b64 exec, 0xff
v_cmp_ne_u32 vcc, s37, v45
s_cmp_eq_u64 vcc, 0
s_cselect_b32 s38, 1, 2
s_mov_b64 exec, -1
v_and_b32 v11, 3, v14
v_mul_u32_u24 v11, 896, v11
v_lshl_add_u32 v11, v15, 4, v11
v_mov_b32 v2, 24612
v_mov_b32 v3, 1
s_mov_b64 exec, 1
ds_add_u32 v2, v3
s_mov_b64 exec, -1
v_mov_b32 v2, 24612
s_mov_b32 s16, 2560000
SW_70:
ds_read_b32 v3, v2
s_waitcnt lgkmcnt(0)
v_cmp_gt_u32 vcc, 4, v3
s_cbranch_vccz SWD_71
s_sub_u32 s16, s16, 1
s_cbranch_scc0 SW_70
SWD_71:
ds_read_b128 v[16:19], v11 offset:19968
ds_read_b128 v[20:23], v11 offset:20032
ds_read_b128 v[24:27], v11 offset:20096
ds_read_b128 v[28:31], v11 offset:20160
ds_read_b128 v[32:35], v11 offset:20224
ds_read_b128 v[36:39], v11 offset:20288
ds_read_b128 v[40:43], v11 offset:20352
s_waitcnt lgkmcnt(6)
v_mfma_f32_16x16x32_bf16 v[160:163], v[48:51], v[16:19], 0
v_mfma_f32_16x16x32_bf16 v[164:167], v[104:107], v[16:19], 0
ds_read_b128 v[16:19], v11 offset:20416
s_waitcnt lgkmcnt(6)
v_mfma_f32_16x16x32_bf16 v[160:163], v[52:55], v[20:23], v[160:163]
v_mfma_f32_16x16x32_bf16 v[164:167], v[108:111], v[20:23], v[164:167]
ds_read_b128 v[20:23], v11 offset:20480
s_waitcnt lgkmcnt(6)
v_mfma_f32_16x16x32_bf16 v[160:163], v[56:59], v[24:27], v[160:163]
v_mfma_f32_16x16x32_bf16 v[164:167], v[112:115], v[24:27], v[164:167]
ds_read_b128 v[24:27], v11 offset:20544
s_waitcnt lgkmcnt(6)
v_mfma_f32_16x16x32_bf16 v[160:163], v[60:63], v[28:31], v[160:163]
v_mfma_f32_16x16x32_bf16 v[164:167], v[116:119], v[28:31], v[164:167]
ds_read_b128 v[28:31], v11 offset:20608
s_waitcnt lgkmcnt(6)
v_mfma_f32_16x16x32_bf16 v[160:163], v[64:67], v[32:35], v[160:163]
v_mfma_f32_16x16x32_bf16 v[164:167], v[120:123], v[32:35], v[164:167]
ds_read_b128 v[32:35], v11 offset:20672
s_waitcnt lgkmcnt(6)
v_mfma_f32_16x16x32_bf16 v[160:163], v[68:71], v[36:39], v[160:163]
v_mfma_f32_16x16x32_bf16 v[164:167], v[124:127], v[36:39], v[164:167]
ds_read_b128 v[36:39], v11 offset:20736
s_waitcnt lgkmcnt(6)
v_mfma_f32_16x16x32_bf16 v[160:163], v[72:75], v[40:43], v[160:163]
v_mfma_f32_16x16x32_bf16 v[164:167], v[128:131], v[40:43], v[164:167]
ds_read_b128 v[40:43], v11 offset:20800
s_waitcnt lgkmcnt(6)
v_mfma_f32_16x16x32_bf16 v[160:163], v[76:79], v[16:19], v[160:163]
v_mfma_f32_16x16x32_bf16 v[164:167], v[132:135], v[16:19], v[164:167]
s_waitcnt lgkmcnt(5)
v_mfma_f32_16x16x32_bf16 v[160:163], v[80:83], v[20:23], v[160:163]
v_mfma_f32_16x16x32_bf16 v[164:167], v[136:139], v[20:23], v[164:167]
s_waitcnt lgkmcnt(4)
v_mfma_f32_16x16x32_bf16 v[160:163], v[84:87], v[24:27], v[160:163]
v_mfma_f32_16x16x32_bf16 v[164:167], v[140:143], v[24:27], v[164:167]
s_waitcnt lgkmcnt(3)
v_mfma_f32_16x16x32_bf16 v[160:163], v[88:91], v[28:31], v[160:163]
v_mfma_f32_16x16x32_bf16 v[164:167], v[144:147], v[28:31], v[164:167]
s_waitcnt lgkmcnt(2)
v_mfma_f32_16x16x32_bf16 v[160:163], v[92:95], v[32:35], v[160:163]
v_mfma_f32_16x16x32_bf16 v[164:167], v[148:151], v[32:35], v[164:167]
s_waitcnt lgkmcnt(1)
v_mfma_f32_16x16x32_bf16 v[160:163], v[96:99], v[36:39], v[160:163]
v_mfma_f32_16x16x32_bf16 v[164:167], v[152:155], v[36:39], v[164:167]
s_waitcnt lgkmcnt(0)
v_mfma_f32_16x16x32_bf16 v[160:163], v[100:103], v[40:43], v[160:163]
v_mfma_f32_16x16x32_bf16 v[164:167], v[156:159], v[40:43], v[164:167]
v_and_b32 v11, 3, v14
v_lshlrev_b32 v11, 14, v11
v_and_b32 v10, 4, v14
v_lshl_add_u32 v11, v10, 4, v11
v_lshl_add_u32 v11, v15, 4, v11
s_lshl_b32 s21, s7, 9
s_lshl_b32 s22, s3, 7
s_add_u32 s21, s21, s22
s_add_u32 s21, s21, 65536
s_mov_b32 s84, 0x00f000f0
s_mov_b32 s85, 0x00f000f0
v_cndmask_b32 v16, v160, v164, s[84:85]
v_cndmask_b32 v17, v161, v165, s[84:85]
v_cndmask_b32 v18, v162, v166, s[84:85]
v_cndmask_b32 v19, v163, v167, s[84:85]
v_cvt_pk_bf16_f32 v20, v16, v17
v_cvt_pk_bf16_f32 v21, v18, v19
v_lshl_or_b32 v16, v20, 16, v1
v_and_or_b32 v17, v20, s81, v1
v_lshl_or_b32 v18, v21, 16, v1
v_and_or_b32 v19, v21, s81, v1
s_mov_b32 exec_lo, 0x00ff00ff
s_mov_b32 exec_hi, 0x00ff00ff
s_cmp_eq_u32 s38, 1
s_cbranch_scc0 L_QF
buffer_store_dwordx4 v[16:19], v11, s[76:79], s21 offen
s_branch L_QG
L_QF:
buffer_store_dwordx4 v[16:19], v11, s[76:79], s21 offen sc1
L_QG:
s_mov_b64 exec, -1
s_cmp_eq_u32 s3, 0
s_cbranch_scc0 L_STAT
v_lshlrev_b32 v12, 4, v0
s_lshl_b32 s22, s10, 14
s_lshl_b32 s23, s11, 11
s_add_u32 s22, s22, s23
s_add_u32 s22, s22, 65536
s_mov_b32 s16, 40000
s_mov_b64 s[0:1], exec
PL_72:
buffer_load_dwordx4 v[20:23], v12, s[76:79], s22 offen offset:0 sc1
buffer_load_dwordx4 v[24:27], v12, s[76:79], s22 offen offset:1024 sc1
s_waitcnt vmcnt(0)
v_bitop3_b32 v44, v20, v21, v1 bitop3:0x7e
v_bitop3_b32 v44, v44, v22, v1 bitop3:0xf6
v_bitop3_b32 v44, v44, v23, v1 bitop3:0xf6
v_bitop3_b32 v44, v44, v24, v1 bitop3:0xf6
v_bitop3_b32 v44, v44, v25, v1 bitop3:0xf6
v_bitop3_b32 v44, v44, v26, v1 bitop3:0xf6
v_bitop3_b32 v44, v44, v27, v1 bitop3:0xf6
v_and_b32 v44, 0xffff, v44
v_cmp_ne_u32 vcc, 0, v44
s_cbranch_vccz PD_73
s_mov_b64 exec, vcc
s_sub_u32 s16, s16, 1
s_cbranch_scc0 PL_72
PD_73:
s_mov_b64 exec, s[0:1]
v_lshlrev_b32 v11, 3, v0
v_perm_b32 v20, v21, v20, s82
v_perm_b32 v21, v23, v22, s82
ds_write_b64 v11, v[20:21] offset:23552
v_perm_b32 v24, v25, v24, s82
v_perm_b32 v25, v27, v26, s82
ds_write_b64 v11, v[24:25] offset:24064
v_mov_b32 v11, 24592
v_mov_b32 v12, 1
ds_write_b32 v11, v12
s_branch L_STAT
L_NOTF:
s_cmp_lt_u32 s4, s5
s_cbranch_scc0 L_NOJOB
s_mov_b32 exec_lo, -1
s_mov_b32 exec_hi, 0x00ffffff
buffer_load_dwordx4 v[16:19], v13, s[64:67], s21 offen nt
s_mov_b64 exec, -1
s_lshr_b32 s20, s10, 1
s_lshl_b32 s20, s20, 3
s_add_u32 s20, s20, s11
s_lshl_b32 s20, s20, 1
s_and_b32 s22, s10, 1
s_add_u32 s20, s20, s22
s_lshl_b32 s19, s6, 5
s_add_u32 s19, s19, s20
v_lshrrev_b32 v10, 2, v0
v_and_b32 v11, 3, v0
v_lshrrev_b32 v12, 5, v0
v_lshlrev_b32 v12, 1, v12
v_xor_b32 v11, v11, v12
v_mul_u32_u24 v10, 5376, v10
v_lshl_add_u32 v11, v11, 4, v10
s_mul_i32 s20, s3, 602112
s_lshl_b32 s22, s19, 6
s_add_u32 s20, s20, s22
s_mul_i32 s22, s3, 7168
s_add_u32 s22, s22, 86272
s_add_u32 m0, s22, 0
s_add_u32 s17, s20, 0
buffer_load_dwordx4 v11, s[68:71], s17 offen nt lds
s_add_u32 m0, s22, 1024
s_add_u32 s17, s20, 86016
buffer_load_dwordx4 v11, s[68:71], s17 offen nt lds
s_add_u32 m0, s22, 2048
s_add_u32 s17, s20, 172032
buffer_load_dwordx4 v11, s[68:71], s17 offen nt lds
s_add_u32 m0, s22, 3072
s_add_u32 s17, s20, 258048
buffer_load_dwordx4 v11, s[68:71], s17 offen nt lds
s_add_u32 m0, s22, 4096
s_add_u32 s17, s20, 344064
buffer_load_dwordx4 v11, s[68:71], s17 offen nt lds
s_add_u32 m0, s22, 5120
s_add_u32 s17, s20, 430080
buffer_load_dwordx4 v11, s[68:71], s17 offen nt lds
s_add_u32 m0, s22, 6144
s_add_u32 s17, s20, 516096
buffer_load_dwordx4 v11, s[68:71], s17 offen nt lds
s_barrier
s_waitcnt vmcnt(7)
v_readfirstlane_b32 s13, v1
s_add_u32 s13, s13, 1
s_and_b32 s17, s13, 0xffff
v_mov_b32 v1, s17
v_lshlrev_b32 v20, 16, v16
v_and_b32 v21, s81, v16
v_lshlrev_b32 v22, 16, v17
v_and_b32 v23, s81, v17
v_lshlrev_b32 v24, 16, v18
v_and_b32 v25, s81, v18
v_lshlrev_b32 v26, 16, v19
v_and_b32 v27, s81, v19
s_mov_b32 s17, 0xbfb8aa3b
v_mul_f32 v28, s17, v20
v_mul_f32 v29, s17, v21
v_mul_f32 v30, s17, v22
v_mul_f32 v31, s17, v23
v_mul_f32 v32, s17, v24
v_mul_f32 v33, s17, v25
v_mul_f32 v34, s17, v26
v_mul_f32 v35, s17, v27
v_exp_f32 v28, v28
v_exp_f32 v29, v29
v_exp_f32 v30, v30
v_exp_f32 v31, v31
v_exp_f32 v32, v32
v_exp_f32 v33, v33
v_exp_f32 v34, v34
v_exp_f32 v35, v35
v_add_f32 v28, 1.0, v28
v_add_f32 v29, 1.0, v29
v_add_f32 v30, 1.0, v30
v_add_f32 v31, 1.0, v31
v_add_f32 v32, 1.0, v32
v_add_f32 v33, 1.0, v33
v_add_f32 v34, 1.0, v34
v_add_f32 v35, 1.0, v35
v_rcp_f32 v28, v28
v_rcp_f32 v29, v29
v_rcp_f32 v30, v30
v_rcp_f32 v31, v31
v_rcp_f32 v32, v32
v_rcp_f32 v33, v33
v_rcp_f32 v34, v34
v_rcp_f32 v35, v35
v_mul_f32 v20, v20, v28
v_mul_f32 v21, v21, v29
v_mul_f32 v22, v22, v30
v_mul_f32 v23, v23, v31
v_mul_f32 v24, v24, v32
v_mul_f32 v25, v25, v33
v_mul_f32 v26, v26, v34
v_mul_f32 v27, v27, v35
v_cvt_pk_bf16_f32 v16, v20, v21
v_cvt_pk_bf16_f32 v17, v22, v23
v_cvt_pk_bf16_f32 v18, v24, v25
v_cvt_pk_bf16_f32 v19, v26, v27
v_add_u32 v13, s21, v13
s_mov_b32 exec_lo, -1
s_mov_b32 exec_hi, 0x00ffffff
ds_write_b128 v13, v[16:19] offset:16384
s_mov_b64 exec, -1
v_and_b32 v5, 1, v15
v_xor_b32 v5, s3, v5
v_lshlrev_b32 v5, 5, v5
v_lshrrev_b32 v4, 2, v14
v_lshl_add_u32 v4, v15, 3, v4
v_lshl_add_u32 v5, v4, 6, v5
v_and_b32 v4, 3, v14
v_lshl_add_u32 v5, v4, 3, v5
v_add_u32 v8, 86272, v5
v_and_b32 v9, 3, v14
v_mul_u32_u24 v9, 896, v9
v_lshl_add_u32 v9, v15, 4, v9
v_mul_u32_u24 v11, 10752, v14
v_lshl_add_u32 v11, v15, 4, v11
s_lshl_b32 s21, s19, 7
s_lshl_b32 s22, s3, 6
s_add_u32 s21, s21, s22
s_add_u32 s21, s21, 16384
s_waitcnt vmcnt(0)
v_mov_b32 v2, 24608
v_mov_b32 v3, 1
s_mov_b64 exec, 1
ds_add_u32 v2, v3
s_mov_b64 exec, -1
s_cmp_lt_u32 s3, 2
s_cbranch_scc0 L_TAILW
v_mov_b32 v2, 24608
s_mov_b32 s16, 2560000
SW_74:
ds_read_b32 v3, v2
s_waitcnt lgkmcnt(0)
v_cmp_gt_u32 vcc, 4, v3
s_cbranch_vccz SWD_75
s_sub_u32 s16, s16, 1
s_cbranch_scc0 SW_74
SWD_75:
ds_read_b64_tr_b16 v[48:49], v8 offset:0
ds_read_b64_tr_b16 v[50:51], v8 offset:256
ds_read_b128 v[104:107], v9 offset:16384
ds_read_b64_tr_b16 v[52:53], v8 offset:2048
ds_read_b64_tr_b16 v[54:55], v8 offset:2304
ds_read_b128 v[108:111], v9 offset:16448
ds_read_b64_tr_b16 v[56:57], v8 offset:4096
ds_read_b64_tr_b16 v[58:59], v8 offset:4352
ds_read_b128 v[112:115], v9 offset:16512
ds_read_b64_tr_b16 v[60:61], v8 offset:6144
ds_read_b64_tr_b16 v[62:63], v8 offset:6400
ds_read_b128 v[116:119], v9 offset:16576
ds_read_b64_tr_b16 v[64:65], v8 offset:8192
ds_read_b64_tr_b16 v[66:67], v8 offset:8448
ds_read_b128 v[120:123], v9 offset:16640
s_waitcnt lgkmcnt(12)
v_mfma_f32_16x16x32_bf16 v[16:19], v[48:51], v[104:107], 0
ds_read_b64_tr_b16 v[68:69], v8 offset:10240
ds_read_b64_tr_b16 v[70:71], v8 offset:10496
ds_read_b128 v[124:127], v9 offset:16704
s_waitcnt lgkmcnt(12)
v_mfma_f32_16x16x32_bf16 v[20:23], v[52:55], v[108:111], 0
ds_read_b64_tr_b16 v[72:73], v8 offset:12288
ds_read_b64_tr_b16 v[74:75], v8 offset:12544
ds_read_b128 v[128:131], v9 offset:16768
s_waitcnt lgkmcnt(12)
v_mfma_f32_16x16x32_bf16 v[16:19], v[56:59], v[112:115], v[16:19]
ds_read_b64_tr_b16 v[76:77], v8 offset:14336
ds_read_b64_tr_b16 v[78:79], v8 offset:14592
ds_read_b128 v[132:135], v9 offset:16832
s_waitcnt lgkmcnt(12)
v_mfma_f32_16x16x32_bf16 v[20:23], v[60:63], v[116:119], v[20:23]
ds_read_b64_tr_b16 v[80:81], v8 offset:16384
ds_read_b64_tr_b16 v[82:83], v8 offset:16640
ds_read_b128 v[136:139], v9 offset:16896
s_waitcnt lgkmcnt(12)
v_mfma_f32_16x16x32_bf16 v[16:19], v[64:67], v[120:123], v[16:19]
ds_read_b64_tr_b16 v[84:85], v8 offset:18432
ds_read_b64_tr_b16 v[86:87], v8 offset:18688
ds_read_b128 v[140:143], v9 offset:16960
s_waitcnt lgkmcnt(12)
v_mfma_f32_16x16x32_bf16 v[20:23], v[68:71], v[124:127], v[20:23]
ds_read_b64_tr_b16 v[88:89], v8 offset:20480
ds_read_b64_tr_b16 v[90:91], v8 offset:20736
ds_read_b128 v[144:147], v9 offset:17024
s_waitcnt lgkmcnt(12)
v_mfma_f32_16x16x32_bf16 v[16:19], v[72:75], v[128:131], v[16:19]
ds_read_b64_tr_b16 v[92:93], v8 offset:22528
ds_read_b64_tr_b16 v[94:95], v8 offset:22784
ds_read_b128 v[148:151], v9 offset:17088
s_waitcnt lgkmcnt(12)
v_mfma_f32_16x16x32_bf16 v[20:23], v[76:79], v[132:135], v[20:23]
ds_read_b64_tr_b16 v[96:97], v8 offset:24576
ds_read_b64_tr_b16 v[98:99], v8 offset:24832
ds_read_b128 v[152:155], v9 offset:17152
s_waitcnt lgkmcnt(12)
v_mfma_f32_16x16x32_bf16 v[16:19], v[80:83], v[136:139], v[16:19]
ds_read_b64_tr_b16 v[100:101], v8 offset:26624
ds_read_b64_tr_b16 v[102:103], v8 offset:26880
ds_read_b128 v[156:159], v9 offset:17216
s_waitcnt lgkmcnt(12)
v_mfma_f32_16x16x32_bf16 v[20:23], v[84:87], v[140:143], v[20:23]
s_waitcnt lgkmcnt(9)
v_mfma_f32_16x16x32_bf16 v[16:19], v[88:91], v[144:147], v[16:19]
s_waitcnt lgkmcnt(6)
v_mfma_f32_16x16x32_bf16 v[20:23], v[92:95], v[148:151], v[20:23]
s_waitcnt lgkmcnt(3)
v_mfma_f32_16x16x32_bf16 v[16:19], v[96:99], v[152:155], v[16:19]
s_waitcnt lgkmcnt(0)
v_mfma_f32_16x16x32_bf16 v[20:23], v[100:103], v[156:159], v[20:23]
v_mov_b32 v2, 24612
v_mov_b32 v3, 1
s_mov_b64 exec, 1
ds_add_u32 v2, v3
s_mov_b64 exec, -1
s_nop 2
v_pk_add_f32 v[16:17], v[16:17], v[20:21]
v_pk_add_f32 v[18:19], v[18:19], v[22:23]
v_cvt_pk_bf16_f32 v20, v16, v17
v_cvt_pk_bf16_f32 v21, v18, v19
v_lshl_or_b32 v16, v20, 16, v1
v_and_or_b32 v17, v20, s81, v1
v_lshl_or_b32 v18, v21, 16, v1
v_and_or_b32 v19, v21, s81, v1
s_mov_b32 exec_lo, 0x000f000f
s_mov_b32 exec_hi, 0x000f000f
buffer_store_dwordx4 v[16:19], v11, s[76:79], s21 offen sc1
s_mov_b64 exec, -1
v_mov_b32 v2, 24612
s_mov_b32 s16, 2560000
SW_76:
ds_read_b32 v3, v2
s_waitcnt lgkmcnt(0)
v_cmp_gt_u32 vcc, 2, v3
s_cbranch_vccz SWD_77
s_sub_u32 s16, s16, 1
s_cbranch_scc0 SW_76
SWD_77:
s_branch L_TAILW
L_NOJOB:
s_barrier
s_waitcnt vmcnt(0)
v_readfirstlane_b32 s13, v1
s_add_u32 s13, s13, 1
s_and_b32 s17, s13, 0xffff
v_mov_b32 v1, s17
L_TAILW:
v_lshrrev_b32 v10, 3, v0
v_mul_u32_u24 v10, 896, v10
v_and_b32 v11, 7, v0
v_lshl_add_u32 v10, v11, 4, v10
v_lshrrev_b32 v9, 2, v0
v_mul_u32_u24 v9, 3584, v9
v_and_b32 v11, 3, v0
v_lshl_add_u32 v9, v11, 4, v9
v_lshlrev_b32 v8, 4, v0
s_lshl_b32 s20, s11, 3
s_add_u32 s20, s20, s3
s_mul_i32 s20, s20, 57344
s_lshl_b32 s21, s6, 7
s_add_u32 s24, s20, s21
s_mul_i32 s20, s3, 401408
s_lshl_b32 s21, s12, 6
s_add_u32 s25, s20, s21
s_mul_i32 s28, s3, 7168
s_mul_i32 s20, s12, 28672
s_add_u32 s26, s20, s28
s_add_u32 s29, s28, 57600
s_add_u32 s28, s28, 28928
s_cmp_eq_u32 s3, 2
s_cselect_b64 vcc, -1, 0
s_cmp_lt_u32 s4, s5
s_cselect_b64 vcc, vcc, 0
s_add_u32 m0, s80, 0
s_add_u32 s17, s24, 0
buffer_load_dwordx4 v10, s[52:55], s17 offen nt lds
s_add_u32 m0, s80, 1024
s_add_u32 s17, s24, 7168
buffer_load_dwordx4 v10, s[52:55], s17 offen nt lds
s_add_u32 m0, s80, 2048
s_add_u32 s17, s24, 14336
buffer_load_dwordx4 v10, s[52:55], s17 offen nt lds
s_add_u32 m0, s80, 3072
s_add_u32 s17, s24, 21504
s_cbranch_vccnz W2_78
s_waitcnt vmcnt(2)
W2_78:
s_waitcnt vmcnt(4)
buffer_load_dwordx4 v10, s[52:55], s17 offen nt lds
s_add_u32 m0, s80, 4096
s_add_u32 s17, s24, 28672
s_cbranch_vccnz W2_79
s_waitcnt vmcnt(2)
W2_79:
s_waitcnt vmcnt(4)
buffer_load_dwordx4 v10, s[52:55], s17 offen nt lds
s_add_u32 m0, s80, 5120
s_add_u32 s17, s24, 35840
s_cbranch_vccnz W2_80
s_waitcnt vmcnt(2)
W2_80:
s_waitcnt vmcnt(4)
buffer_load_dwordx4 v10, s[52:55], s17 offen nt lds
s_add_u32 m0, s80, 6144
s_add_u32 s17, s24, 43008
s_cbranch_vccnz W2_81
s_waitcnt vmcnt(2)
W2_81:
s_waitcnt vmcnt(4)
buffer_load_dwordx4 v10, s[52:55], s17 offen nt lds
s_add_u32 m0, s80, 7168
s_add_u32 s17, s24, 50176
s_cbranch_vccnz W2_82
s_waitcnt vmcnt(2)
W2_82:
s_waitcnt vmcnt(4)
buffer_load_dwordx4 v10, s[52:55], s17 offen nt lds
s_add_u32 m0, s80, 8192
s_add_u32 s17, s24, 229376
s_cbranch_vccnz W2_83
s_waitcnt vmcnt(2)
W2_83:
s_waitcnt vmcnt(4)
buffer_load_dwordx4 v10, s[52:55], s17 offen nt lds
s_add_u32 m0, s80, 9216
s_add_u32 s17, s24, 236544
s_cbranch_vccnz W2_84
s_waitcnt vmcnt(2)
W2_84:
s_waitcnt vmcnt(4)
buffer_load_dwordx4 v10, s[52:55], s17 offen nt lds
s_add_u32 m0, s80, 10240
s_add_u32 s17, s24, 243712
s_cbranch_vccnz W2_85
s_waitcnt vmcnt(2)
W2_85:
s_waitcnt vmcnt(4)
buffer_load_dwordx4 v10, s[52:55], s17 offen nt lds
s_add_u32 m0, s80, 11264
s_add_u32 s17, s24, 250880
s_cbranch_vccnz W2_86
s_waitcnt vmcnt(2)
W2_86:
s_waitcnt vmcnt(4)
buffer_load_dwordx4 v10, s[52:55], s17 offen nt lds
s_cmp_eq_u32 s3, 0
s_cbranch_scc0 NQ_87
v_lshlrev_b32 v12, 4, v0
s_lshl_b32 s22, s10, 14
s_lshl_b32 s23, s11, 11
s_add_u32 s22, s22, s23
s_add_u32 s22, s22, 65536
s_mov_b32 s16, 40000
s_mov_b64 s[0:1], exec
PL_88:
buffer_load_dwordx4 v[20:23], v12, s[76:79], s22 offen offset:0 sc1
buffer_load_dwordx4 v[24:27], v12, s[76:79], s22 offen offset:1024 sc1
s_waitcnt vmcnt(0)
v_bitop3_b32 v44, v20, v21, v1 bitop3:0x7e
v_bitop3_b32 v44, v44, v22, v1 bitop3:0xf6
v_bitop3_b32 v44, v44, v23, v1 bitop3:0xf6
v_bitop3_b32 v44, v44, v24, v1 bitop3:0xf6
v_bitop3_b32 v44, v44, v25, v1 bitop3:0xf6
v_bitop3_b32 v44, v44, v26, v1 bitop3:0xf6
v_bitop3_b32 v44, v44, v27, v1 bitop3:0xf6
v_and_b32 v44, 0xffff, v44
v_cmp_ne_u32 vcc, 0, v44
s_cbranch_vccz PD_89
s_mov_b64 exec, vcc
s_sub_u32 s16, s16, 1
s_cbranch_scc0 PL_88
PD_89:
s_mov_b64 exec, s[0:1]
v_lshlrev_b32 v11, 3, v0
v_perm_b32 v20, v21, v20, s82
v_perm_b32 v21, v23, v22, s82
ds_write_b64 v11, v[20:21] offset:23552
v_perm_b32 v24, v25, v24, s82
v_perm_b32 v25, v27, v26, s82
ds_write_b64 v11, v[24:25] offset:24064
v_mov_b32 v11, 24592
v_mov_b32 v12, 1
ds_write_b32 v11, v12
NQ_87:
s_add_u32 m0, s80, 12288
s_add_u32 s17, s24, 258048
s_cbranch_vccnz W2_90
s_waitcnt vmcnt(2)
W2_90:
s_waitcnt vmcnt(4)
buffer_load_dwordx4 v10, s[52:55], s17 offen nt lds
s_add_u32 m0, s80, 13312
s_add_u32 s17, s24, 265216
s_cbranch_vccnz W2_91
s_waitcnt vmcnt(2)
W2_91:
s_waitcnt vmcnt(4)
buffer_load_dwordx4 v10, s[52:55], s17 offen nt lds
s_add_u32 m0, s80, 14336
s_add_u32 s17, s24, 272384
s_cbranch_vccnz W2_92
s_waitcnt vmcnt(2)
W2_92:
s_waitcnt vmcnt(4)
buffer_load_dwordx4 v10, s[52:55], s17 offen nt lds
s_add_u32 m0, s80, 15360
s_add_u32 s17, s24, 279552
s_cbranch_vccnz W2_93
s_waitcnt vmcnt(2)
W2_93:
s_waitcnt vmcnt(4)
buffer_load_dwordx4 v10, s[52:55], s17 offen nt lds
s_add_u32 m0, s28, 0
s_add_u32 s17, s25, 0
s_cbranch_vccnz W2_94
s_waitcnt vmcnt(2)
W2_94:
s_waitcnt vmcnt(4)
buffer_load_dwordx4 v9, s[56:59], s17 offen nt lds
s_add_u32 m0, s28, 1024
s_add_u32 s17, s25, 57344
s_cbranch_vccnz W2_95
s_waitcnt vmcnt(2)
W2_95:
s_waitcnt vmcnt(4)
buffer_load_dwordx4 v9, s[56:59], s17 offen nt lds
s_add_u32 m0, s28, 2048
s_add_u32 s17, s25, 114688
s_cbranch_vccnz W2_96
s_waitcnt vmcnt(2)
W2_96:
s_waitcnt vmcnt(4)
buffer_load_dwordx4 v9, s[56:59], s17 offen nt lds
s_add_u32 m0, s28, 3072
s_add_u32 s17, s25, 172032
s_cbranch_vccnz W2_97
s_waitcnt vmcnt(2)
W2_97:
s_waitcnt vmcnt(4)
buffer_load_dwordx4 v9, s[56:59], s17 offen nt lds
s_add_u32 m0, s28, 4096
s_add_u32 s17, s25, 229376
s_cbranch_vccnz W2_98
s_waitcnt vmcnt(2)
W2_98:
s_waitcnt vmcnt(4)
buffer_load_dwordx4 v9, s[56:59], s17 offen nt lds
s_add_u32 m0, s28, 5120
s_add_u32 s17, s25, 286720
s_cbranch_vccnz W2_99
s_waitcnt vmcnt(2)
W2_99:
s_waitcnt vmcnt(4)
buffer_load_dwordx4 v9, s[56:59], s17 offen nt lds
s_add_u32 m0, s28, 6144
s_add_u32 s17, s25, 344064
s_cbranch_vccnz W2_100
s_waitcnt vmcnt(2)
W2_100:
s_waitcnt vmcnt(4)
buffer_load_dwordx4 v9, s[56:59], s17 offen nt lds
s_add_u32 m0, s29, 0
s_add_u32 s17, s26, 0
s_cbranch_vccnz W2_101
s_waitcnt vmcnt(2)
W2_101:
s_waitcnt vmcnt(4)
buffer_load_dwordx4 v8, s[60:63], s17 offen nt lds
s_add_u32 m0, s29, 1024
s_add_u32 s17, s26, 1024
s_cbranch_vccnz W2_102
s_waitcnt vmcnt(2)
W2_102:
s_waitcnt vmcnt(4)
buffer_load_dwordx4 v8, s[60:63], s17 offen nt lds
s_add_u32 m0, s29, 2048
s_add_u32 s17, s26, 2048
s_cbranch_vccnz W2_103
s_waitcnt vmcnt(2)
W2_103:
s_waitcnt vmcnt(4)
buffer_load_dwordx4 v8, s[60:63], s17 offen nt lds
s_add_u32 m0, s29, 3072
s_add_u32 s17, s26, 3072
s_cbranch_vccnz W2_104
s_waitcnt vmcnt(2)
W2_104:
s_waitcnt vmcnt(4)
buffer_load_dwordx4 v8, s[60:63], s17 offen nt lds
s_cmp_eq_u32 s3, 2
s_cbranch_scc0 NX_105
s_mov_b64 exec, 0xff
global_load_dword v45, v46, s[42:43] sc1
s_mov_b64 exec, -1
NX_105:
s_add_u32 m0, s29, 4096
s_add_u32 s17, s26, 4096
s_cbranch_vccnz W2_106
s_waitcnt vmcnt(2)
W2_106:
s_waitcnt vmcnt(4)
buffer_load_dwordx4 v8, s[60:63], s17 offen nt lds
s_add_u32 m0, s29, 5120
s_add_u32 s17, s26, 5120
s_cbranch_vccnz W2_107
s_waitcnt vmcnt(2)
W2_107:
s_waitcnt vmcnt(4)
buffer_load_dwordx4 v8, s[60:63], s17 offen nt lds
s_add_u32 m0, s29, 6144
s_add_u32 s17, s26, 6144
s_cbranch_vccnz W2_108
s_waitcnt vmcnt(2)
W2_108:
s_waitcnt vmcnt(4)
buffer_load_dwordx4 v8, s[60:63], s17 offen nt lds
v_and_b32 v10, 1, v15
v_lshlrev_b32 v11, 12, v10
v_lshrrev_b32 v10, 1, v15
v_lshl_add_u32 v11, v10, 11, v11
v_bfe_u32 v10, v14, 2, 1
v_lshl_add_u32 v11, v10, 10, v11
v_lshrrev_b32 v10, 3, v14
v_lshl_add_u32 v11, v10, 7, v11
v_and_b32 v12, 3, v14
v_lshl_add_u32 v11, v12, 3, v11
v_add_u32 v11, s80, v11
s_waitcnt vmcnt(0)
v_mov_b32 v2, 24616
v_mov_b32 v3, 1
s_mov_b64 exec, 1
ds_add_u32 v2, v3
s_mov_b64 exec, -1
ds_read_b64_tr_b16 v[48:49], v11 offset:0
ds_read_b64_tr_b16 v[50:51], v11 offset:256
ds_read_b64_tr_b16 v[52:53], v11 offset:512
ds_read_b64_tr_b16 v[54:55], v11 offset:768
ds_read_b64_tr_b16 v[56:57], v11 offset:8192
ds_read_b64_tr_b16 v[58:59], v11 offset:8448
ds_read_b64_tr_b16 v[60:61], v11 offset:8704
ds_read_b64_tr_b16 v[62:63], v11 offset:8960
ds_read_b64_tr_b16 v[64:65], v11 offset:32
ds_read_b64_tr_b16 v[66:67], v11 offset:288
ds_read_b64_tr_b16 v[68:69], v11 offset:544
ds_read_b64_tr_b16 v[70:71], v11 offset:800
ds_read_b64_tr_b16 v[72:73], v11 offset:8224
ds_read_b64_tr_b16 v[74:75], v11 offset:8480
ds_read_b64_tr_b16 v[76:77], v11 offset:8736
ds_read_b64_tr_b16 v[78:79], v11 offset:8992
ds_read_b64_tr_b16 v[80:81], v11 offset:64
ds_read_b64_tr_b16 v[82:83], v11 offset:320
ds_read_b64_tr_b16 v[84:85], v11 offset:576
ds_read_b64_tr_b16 v[86:87], v11 offset:832
ds_read_b64_tr_b16 v[88:89], v11 offset:8256
ds_read_b64_tr_b16 v[90:91], v11 offset:8512
ds_read_b64_tr_b16 v[92:93], v11 offset:8768
ds_read_b64_tr_b16 v[94:95], v11 offset:9024
ds_read_b64_tr_b16 v[96:97], v11 offset:96
ds_read_b64_tr_b16 v[98:99], v11 offset:352
ds_read_b64_tr_b16 v[100:101], v11 offset:608
ds_read_b64_tr_b16 v[102:103], v11 offset:864
ds_read_b64_tr_b16 v[104:105], v11 offset:8288
ds_read_b64_tr_b16 v[106:107], v11 offset:8544
ds_read_b64_tr_b16 v[108:109], v11 offset:8800
ds_read_b64_tr_b16 v[110:111], v11 offset:9056
L_STAT:
s_cmp_eq_u32 s3, 2
s_cbranch_scc0 L_NOSTAT
s_getreg_b32 s37, hwreg(HW_REG_XCC_ID, 0, 4)
s_add_u32 s37, s37, 1
s_mul_i32 s37, s37, 0x01010101
s_mov_b64 exec, 0xff
v_cmp_ne_u32 vcc, s37, v45
s_cmp_eq_u64 vcc, 0
s_cselect_b32 s38, 1, 2
s_mov_b64 exec, -1
v_mov_b32 v22, s38
v_mov_b32 v23, 24596
ds_write_b32 v23, v22
s_mov_b64 exec, 0xffff
v_lshlrev_b32 v11, 3, v0
s_lshl_b32 s19, s8, 7
s_add_u32 s19, s19, 131072
s_lshl_b32 s18, s9, 4
s_add_u32 s18, s18, s19
s_mov_b32 s17, 0x3db8aa3b
s_mov_b32 s16, 2560000
SW_109:
ds_read_b64 v[16:17], v11 offset:24640
s_waitcnt lgkmcnt(0)
v_cmp_eq_u32 vcc, 0, v17
s_cbranch_vccz SWD_110
s_sub_u32 s16, s16, 1
s_cbranch_scc0 SW_109
SWD_110:
v_mov_b32 v20, v16
s_nop 1
v_max_f32_dpp v20, v20, v20 row_ror:2 row_mask:0xf bank_mask:0xf
s_nop 1
v_max_f32_dpp v20, v20, v20 row_ror:4 row_mask:0xf bank_mask:0xf
s_nop 1
v_max_f32_dpp v20, v20, v20 row_ror:8 row_mask:0xf bank_mask:0xf
v_sub_f32 v16, v16, v20
v_mul_f32 v16, s17, v16
v_exp_f32 v16, v16
s_nop 0
v_mul_f32 v21, v16, v17
s_nop 1
v_add_f32_dpp v21, v21, v21 row_ror:2 row_mask:0xf bank_mask:0xf
s_nop 1
v_add_f32_dpp v21, v21, v21 row_ror:4 row_mask:0xf bank_mask:0xf
s_nop 1
v_add_f32_dpp v21, v21, v21 row_ror:8 row_mask:0xf bank_mask:0xf
v_or_b32 v24, v20, v1
v_bfi_b32 v25, s15, v1, v21
s_mov_b64 exec, 3
s_cmp_eq_u32 s38, 1
s_cbranch_scc0 L_MF
buffer_store_dwordx2 v[24:25], v11, s[76:79], s18 offen
s_branch L_MG
L_MF:
buffer_store_dwordx2 v[24:25], v11, s[76:79], s18 offen sc1
L_MG:
s_mov_b64 exec, 0xffff
s_mov_b32 s16, 40000
L_MV:
buffer_load_dwordx2 v[16:17], v11, s[76:79], s19 offen sc1
s_waitcnt vmcnt(0)
v_xor_b32 v22, v16, v1
v_xor_b32 v23, v17, v1
v_and_b32 v22, 0xffff, v22
v_and_or_b32 v22, v23, s15, v22
v_cmp_ne_u32 vcc, 0, v22
s_cbranch_vccz L_MH
s_sub_u32 s16, s16, 1
s_cbranch_scc0 L_MV
L_MH:
v_and_b32 v16, s81, v16
v_and_b32 v17, s14, v17
v_mov_b32 v20, v16
s_nop 1
v_max_f32_dpp v20, v20, v20 row_ror:2 row_mask:0xf bank_mask:0xf
s_nop 1
v_max_f32_dpp v20, v20, v20 row_ror:4 row_mask:0xf bank_mask:0xf
s_nop 1
v_max_f32_dpp v20, v20, v20 row_ror:8 row_mask:0xf bank_mask:0xf
v_sub_f32 v16, v16, v20
v_mul_f32 v16, s17, v16
v_exp_f32 v16, v16
s_nop 0
v_mul_f32 v21, v16, v17
s_nop 1
v_add_f32_dpp v21, v21, v21 row_ror:2 row_mask:0xf bank_mask:0xf
s_nop 1
v_add_f32_dpp v21, v21, v21 row_ror:4 row_mask:0xf bank_mask:0xf
s_nop 1
v_add_f32_dpp v21, v21, v21 row_ror:8 row_mask:0xf bank_mask:0xf
v_rcp_f32 v21, v21
s_mov_b64 exec, 3
ds_write_b64 v11, v[20:21] offset:24576
s_mov_b64 exec, -1
L_NOSTAT:
s_mov_b32 s18, 0
s_cmp_eq_u32 s4, 0
s_cbranch_scc1 L_NOMODG
v_mov_b32 v2, 24616
s_mov_b32 s16, 2560000
SW_111:
ds_read_b32 v3, v2
s_waitcnt lgkmcnt(0)
v_cmp_gt_u32 vcc, 4, v3
s_cbranch_vccz SWD_112
s_sub_u32 s16, s16, 1
s_cbranch_scc0 SW_111
SWD_112:
v_lshrrev_b32 v10, 2, v14
v_and_b32 v12, 3, v14
v_lshl_add_u32 v11, v15, 3, v10
v_lshlrev_b32 v11, 6, v11
v_lshl_add_u32 v11, v12, 3, v11
s_lshr_b32 s20, s3, 1
s_mul_i32 s20, s20, 14336
s_and_b32 s21, s3, 1
s_lshl_b32 s21, s21, 5
s_add_u32 s20, s20, s21
s_add_u32 s20, s20, 28928
v_add_u32 v11, s20, v11
ds_read_b64_tr_b16 v[112:113], v11 offset:0
ds_read_b64_tr_b16 v[114:115], v11 offset:256
ds_read_b64_tr_b16 v[116:117], v11 offset:2048
ds_read_b64_tr_b16 v[118:119], v11 offset:2304
ds_read_b64_tr_b16 v[120:121], v11 offset:4096
ds_read_b64_tr_b16 v[122:123], v11 offset:4352
ds_read_b64_tr_b16 v[124:125], v11 offset:6144
ds_read_b64_tr_b16 v[126:127], v11 offset:6400
ds_read_b64_tr_b16 v[128:129], v11 offset:8192
ds_read_b64_tr_b16 v[130:131], v11 offset:8448
ds_read_b64_tr_b16 v[132:133], v11 offset:10240
ds_read_b64_tr_b16 v[134:135], v11 offset:10496
ds_read_b64_tr_b16 v[136:137], v11 offset:12288
ds_read_b64_tr_b16 v[138:139], v11 offset:12544
v_lshl_add_u32 v10, v15, 2, v10
v_mul_u32_u24 v10, 896, v10
v_lshl_add_u32 v11, v12, 3, v10
s_mul_i32 s20, s3, 224
s_add_u32 s20, s20, 57600
v_add_u32 v11, s20, v11
ds_read_b64_tr_b16 v[140:141], v11 offset:0
ds_read_b64_tr_b16 v[142:143], v11 offset:14336
ds_read_b64_tr_b16 v[144:145], v11 offset:32
ds_read_b64_tr_b16 v[146:147], v11 offset:14368
ds_read_b64_tr_b16 v[148:149], v11 offset:64
ds_read_b64_tr_b16 v[150:151], v11 offset:14400
ds_read_b64_tr_b16 v[152:153], v11 offset:96
ds_read_b64_tr_b16 v[154:155], v11 offset:14432
ds_read_b64_tr_b16 v[156:157], v11 offset:128
ds_read_b64_tr_b16 v[158:159], v11 offset:14464
ds_read_b64_tr_b16 v[160:161], v11 offset:160
ds_read_b64_tr_b16 v[162:163], v11 offset:14496
ds_read_b64_tr_b16 v[164:165], v11 offset:192
ds_read_b64_tr_b16 v[166:167], v11 offset:14528
v_mov_b32 v2, 0
v_mov_b32 v3, 0
v_mov_b32 v4, 0
v_mov_b32 v5, 0
v_mov_b32 v6, 0
v_mov_b32 v7, 0
v_mov_b32 v8, 0
v_mov_b32 v9, 0
v_and_b32 v11, 31, v0
s_mul_i32 s20, s3, 28
v_add_u32 v11, s20, v11
v_lshlrev_b32 v12, 4, v11
v_lshrrev_b32 v10, 5, v0
v_lshlrev_b32 v10, 2, v10
v_lshl_add_u32 v10, v11, 3, v10
s_mul_i32 s20, s10, 10752
s_add_u32 s20, s20, 19968
s_mul_i32 s21, s10, 896
s_mov_b32 exec_lo, 0x0fffffff
s_mov_b32 exec_hi, 0x0fffffff
buffer_load_dword v28, v10, s[44:47], s21 offen nt
s_mov_b32 s16, 40000
s_mov_b64 s[0:1], exec
PL_113:
buffer_load_dwordx4 v[16:19], v12, s[76:79], s20 offen offset:0 sc1
buffer_load_dwordx4 v[20:23], v12, s[76:79], s20 offen offset:1792 sc1
buffer_load_dwordx4 v[24:27], v12, s[76:79], s20 offen offset:3584 sc1
s_waitcnt vmcnt(0)
v_bitop3_b32 v44, v16, v17, v1 bitop3:0x7e
v_bitop3_b32 v44, v44, v18, v1 bitop3:0xf6
v_bitop3_b32 v44, v44, v19, v1 bitop3:0xf6
v_bitop3_b32 v44, v44, v20, v1 bitop3:0xf6
v_bitop3_b32 v44, v44, v21, v1 bitop3:0xf6
v_bitop3_b32 v44, v44, v22, v1 bitop3:0xf6
v_bitop3_b32 v44, v44, v23, v1 bitop3:0xf6
v_bitop3_b32 v44, v44, v24, v1 bitop3:0xf6
v_bitop3_b32 v44, v44, v25, v1 bitop3:0xf6
v_bitop3_b32 v44, v44, v26, v1 bitop3:0xf6
v_bitop3_b32 v44, v44, v27, v1 bitop3:0xf6
v_and_b32 v44, 0xffff, v44
v_cmp_ne_u32 vcc, 0, v44
s_cbranch_vccz PD_114
s_mov_b64 exec, vcc
s_sub_u32 s16, s16, 1
s_cbranch_scc0 PL_113
PD_114:
s_mov_b64 exec, s[0:1]
s_mov_b32 s84, 0
s_mov_b32 s85, -1
v_cndmask_b32 v2, v16, v18, s[84:85]
v_and_b32 v2, s81, v2
v_cndmask_b32 v3, v17, v19, s[84:85]
v_and_b32 v3, s81, v3
v_cndmask_b32 v6, v20, v22, s[84:85]
v_and_b32 v6, s81, v6
v_cndmask_b32 v7, v21, v23, s[84:85]
v_and_b32 v7, s81, v7
v_cndmask_b32 v4, v24, v26, s[84:85]
v_and_b32 v4, s81, v4
v_cndmask_b32 v5, v25, v27, s[84:85]
v_and_b32 v5, s81, v5
v_add_f32 v4, 1.0, v4
v_add_f32 v5, 1.0, v5
v_cvt_pk_bf16_f32 v30, v4, v5
v_lshlrev_b32 v4, 16, v30
v_and_b32 v5, s81, v30
v_lshlrev_b32 v8, 16, v28
v_and_b32 v9, s81, v28
s_mov_b64 exec, -1
s_cmp_lt_u32 s12, 32
s_cselect_b32 s18, 1, 0
s_cmp_eq_u32 s3, 3
s_cselect_b32 s18, s18, 0
s_cmp_eq_u32 s18, 0
s_cbranch_scc1 L_NOMODG
s_lshr_b32 s21, s12, 3
s_mul_i32 s21, s21, 112
s_bfe_u32 s22, s12, 0x10002
s_lshl_b32 s23, s22, 6
s_add_u32 s21, s21, s23
s_and_b32 s23, s12, 3
s_lshl_b32 s23, s23, 2
s_add_u32 s19, s21, s23
s_cmp_eq_u32 s22, 0
s_cselect_b32 s83, -1, 0xffff
v_lshlrev_b32 v12, 4, v15
v_add_u32 v12, s19, v12
v_lshlrev_b32 v12, 2, v12
s_add_u32 s20, s20, 5376
s_mov_b32 exec_hi, s83
s_mov_b32 s16, 40000
s_mov_b64 s[0:1], exec
PL_115:
buffer_load_dwordx4 v[16:19], v12, s[76:79], s20 offen sc1
s_waitcnt vmcnt(0)
v_bitop3_b32 v44, v16, v17, v1 bitop3:0x7e
v_bitop3_b32 v44, v44, v18, v1 bitop3:0xf6
v_bitop3_b32 v44, v44, v19, v1 bitop3:0xf6
v_and_b32 v44, 0xffff, v44
v_cmp_ne_u32 vcc, 0, v44
s_cbranch_vccz PD_116
s_mov_b64 exec, vcc
s_sub_u32 s16, s16, 1
s_cbranch_scc0 PL_115
PD_116:
s_mov_b64 exec, s[0:1]
v_and_b32 v11, 3, v0
v_cmp_eq_u32 vcc, 1, v11
s_nop 1
v_cndmask_b32 v16, v16, v17, vcc
v_cmp_eq_u32 vcc, 2, v11
s_nop 1
v_cndmask_b32 v16, v16, v18, vcc
v_cmp_eq_u32 vcc, 3, v11
s_nop 1
v_cndmask_b32 v16, v16, v19, vcc
v_and_b32 v10, s81, v16
s_mov_b64 exec, -1
L_NOMODG:
s_cmp_eq_u32 s3, 1
s_cbranch_scc0 L_WARMD
s_mov_b64 exec, 0
s_branch L_PAD0
.fill ((16380 - (. - adaLN_cond__gqa_block_cached__dense_activation_relu__decode_kernel)) >> 2), 4, 0xbf810000
L_WARMR:
s_mov_b64 exec, -1
L_WARMD:
L_PAD0:
s_cbranch_execz L_PAD1
v_and_b32 v12, 31, v0
v_lshlrev_b32 v12, 4, v12
s_lshl_b32 s20, s3, 9
v_add_u32 v12, s20, v12
v_lshrrev_b32 v16, 5, v0
v_lshl_add_u32 v11, v16, 13, v12
v_lshl_add_u32 v13, v16, 3, v12
v_lshl_add_u32 v12, v16, 11, v12
s_lshl_b32 s20, s2, 11
s_add_u32 s20, s20, 262144
s_lshl_b32 s32, s8, 14
s_add_u32 s32, s32, 262144
s_add_u32 s33, s32, 4096
s_add_u32 s34, s32, 8192
s_add_u32 s35, s32, 12288
s_bitcmp1_b32 s9, 0
s_cselect_b32 s22, -1, 0
s_not_b32 s23, s22
s_lshr_b32 s21, s9, 1
s_cmp_eq_u32 s21, 0
s_cselect_b64 s[24:25], s[22:23], -1
s_cmp_eq_u32 s21, 1
s_cselect_b64 s[26:27], s[22:23], -1
s_cmp_eq_u32 s21, 2
s_cselect_b64 s[28:29], s[22:23], -1
s_cmp_eq_u32 s21, 3
s_cselect_b64 s[30:31], s[22:23], -1
v_mov_b32 v32, 0
v_mov_b32 v33, 0
v_mov_b32 v34, 0
v_mov_b32 v35, 0
v_mov_b32 v36, 0
v_mov_b32 v37, 0
v_mov_b32 v38, 0
v_mov_b32 v39, 0
v_mov_b32 v40, 0
v_mov_b32 v41, 0
v_mov_b32 v42, 0
v_mov_b32 v43, 0
v_mov_b32 v44, 0
v_mov_b32 v45, 0
v_mov_b32 v46, 0
v_mov_b32 v47, 0
v_mov_b32 v20, 24596
s_waitcnt lgkmcnt(0)
s_barrier
ds_read_b32 v47, v20
ds_read_b128 v[16:19], v11 offset:0
ds_read_b128 v[20:23], v11 offset:2048
ds_read_b128 v[24:27], v11 offset:4096
ds_read_b128 v[28:31], v11 offset:6144
s_waitcnt lgkmcnt(2)
v_pk_add_f32 v[16:17], v[16:17], v[20:21]
v_pk_add_f32 v[18:19], v[18:19], v[22:23]
v_readfirstlane_b32 s36, v47
v_mov_b32 v47, 0
s_waitcnt lgkmcnt(0)
v_pk_add_f32 v[24:25], v[24:25], v[28:29]
v_pk_add_f32 v[26:27], v[26:27], v[30:31]
v_pk_add_f32 v[16:17], v[16:17], v[24:25]
v_pk_add_f32 v[18:19], v[18:19], v[26:27]
s_nop 1
v_permlane32_swap_b32 v16, v18
v_permlane32_swap_b32 v17, v19
v_pk_add_f32 v[16:17], v[16:17], v[18:19]
s_cmp_eq_u32 s36, 1
v_bfi_b32 v18, s15, v1, v16
v_bfi_b32 v19, s15, v1, v17
s_cbranch_scc0 L_T0F
buffer_store_dwordx2 v[18:19], v13, s[76:79], s20 offen
s_branch L_T0G
L_T0F:
buffer_store_dwordx2 v[18:19], v13, s[76:79], s20 offen sc1
L_T0G:
s_cmp_eq_u32 s4, 0
s_cbranch_scc1 L_FEND
v_and_b32 v16, s14, v16
v_and_b32 v17, s14, v17
s_mov_b32 s16, 40000
PL_117:
s_mov_b64 exec, s[24:25]
s_cbranch_execz PS_120
buffer_load_dwordx4 v[32:35], v12, s[76:79], s32 offen sc1
PS_120:
s_mov_b64 exec, s[26:27]
s_cbranch_execz PS_121
buffer_load_dwordx4 v[36:39], v12, s[76:79], s33 offen sc1
PS_121:
s_mov_b64 exec, s[28:29]
s_cbranch_execz PS_122
buffer_load_dwordx4 v[40:43], v12, s[76:79], s34 offen sc1
PS_122:
s_mov_b64 exec, s[30:31]
s_cbranch_execz PS_123
buffer_load_dwordx4 v[44:47], v12, s[76:79], s35 offen sc1
PS_123:
PW_119:
s_waitcnt vmcnt(0)
s_mov_b64 exec, s[24:25]
s_cbranch_execz PS_124
v_bitop3_b32 v11, v32, v33, v1 bitop3:0x7e
v_bitop3_b32 v11, v11, v34, v1 bitop3:0xf6
v_bitop3_b32 v11, v11, v35, v1 bitop3:0xf6
v_and_b32 v11, s15, v11
v_cmp_ne_u32 s[24:25], 0, v11
v_and_b32 v32, s14, v32
v_and_b32 v33, s14, v33
v_and_b32 v34, s14, v34
v_and_b32 v35, s14, v35
PS_124:
s_mov_b64 exec, s[26:27]
s_cbranch_execz PS_125
v_bitop3_b32 v11, v36, v37, v1 bitop3:0x7e
v_bitop3_b32 v11, v11, v38, v1 bitop3:0xf6
v_bitop3_b32 v11, v11, v39, v1 bitop3:0xf6
v_and_b32 v11, s15, v11
v_cmp_ne_u32 s[26:27], 0, v11
v_and_b32 v36, s14, v36
v_and_b32 v37, s14, v37
v_and_b32 v38, s14, v38
v_and_b32 v39, s14, v39
PS_125:
s_mov_b64 exec, s[28:29]
s_cbranch_execz PS_126
v_bitop3_b32 v11, v40, v41, v1 bitop3:0x7e
v_bitop3_b32 v11, v11, v42, v1 bitop3:0xf6
v_bitop3_b32 v11, v11, v43, v1 bitop3:0xf6
v_and_b32 v11, s15, v11
v_cmp_ne_u32 s[28:29], 0, v11
v_and_b32 v40, s14, v40
v_and_b32 v41, s14, v41
v_and_b32 v42, s14, v42
v_and_b32 v43, s14, v43
PS_126:
s_mov_b64 exec, s[30:31]
s_cbranch_execz PS_127
v_bitop3_b32 v11, v44, v45, v1 bitop3:0x7e
v_bitop3_b32 v11, v11, v46, v1 bitop3:0xf6
v_bitop3_b32 v11, v11, v47, v1 bitop3:0xf6
v_and_b32 v11, s15, v11
v_cmp_ne_u32 s[30:31], 0, v11
v_and_b32 v44, s14, v44
v_and_b32 v45, s14, v45
v_and_b32 v46, s14, v46
v_and_b32 v47, s14, v47
PS_127:
s_or_b64 s[0:1], s[24:25], s[26:27]
s_or_b64 s[0:1], s[0:1], s[28:29]
s_or_b64 s[0:1], s[0:1], s[30:31]
s_cbranch_scc0 PX_118
s_sub_u32 s16, s16, 1
s_cbranch_scc1 PX_118
s_cmp_lg_u64 s[24:25], 0
s_cselect_b32 s17, 1, 0
s_cmp_lg_u64 s[26:27], 0
s_addc_u32 s17, s17, 0
s_cmp_lg_u64 s[28:29], 0
s_addc_u32 s17, s17, 0
s_cmp_lg_u64 s[30:31], 0
s_addc_u32 s17, s17, 0
s_cmp_eq_u32 s17, 1
s_cbranch_scc0 PL_117
s_mov_b64 exec, s[24:25]
s_cbranch_execnz PT_128
s_mov_b64 exec, s[26:27]
s_cbranch_execnz PT_129
s_mov_b64 exec, s[28:29]
s_cbranch_execnz PT_130
s_mov_b64 exec, s[30:31]
PT_131:
buffer_load_dwordx4 v[44:47], v12, s[76:79], s35 offen sc1
s_waitcnt vmcnt(0)
v_bitop3_b32 v11, v44, v45, v1 bitop3:0x7e
v_bitop3_b32 v11, v11, v46, v1 bitop3:0xf6
v_bitop3_b32 v11, v11, v47, v1 bitop3:0xf6
v_and_b32 v11, s15, v11
v_cmp_ne_u32 vcc, 0, v11
v_and_b32 v44, s14, v44
v_and_b32 v45, s14, v45
v_and_b32 v46, s14, v46
v_and_b32 v47, s14, v47
s_cbranch_vccz PX_118
s_mov_b64 exec, vcc
s_sub_u32 s16, s16, 1
s_cbranch_scc0 PT_131
s_branch PX_118
PT_128:
buffer_load_dwordx4 v[32:35], v12, s[76:79], s32 offen sc1
s_waitcnt vmcnt(0)
v_bitop3_b32 v11, v32, v33, v1 bitop3:0x7e
v_bitop3_b32 v11, v11, v34, v1 bitop3:0xf6
v_bitop3_b32 v11, v11, v35, v1 bitop3:0xf6
v_and_b32 v11, s15, v11
v_cmp_ne_u32 vcc, 0, v11
v_and_b32 v32, s14, v32
v_and_b32 v33, s14, v33
v_and_b32 v34, s14, v34
v_and_b32 v35, s14, v35
s_cbranch_vccz PX_118
s_mov_b64 exec, vcc
s_sub_u32 s16, s16, 1
s_cbranch_scc0 PT_128
s_branch PX_118
PT_129:
buffer_load_dwordx4 v[36:39], v12, s[76:79], s33 offen sc1
s_waitcnt vmcnt(0)
v_bitop3_b32 v11, v36, v37, v1 bitop3:0x7e
v_bitop3_b32 v11, v11, v38, v1 bitop3:0xf6
v_bitop3_b32 v11, v11, v39, v1 bitop3:0xf6
v_and_b32 v11, s15, v11
v_cmp_ne_u32 vcc, 0, v11
v_and_b32 v36, s14, v36
v_and_b32 v37, s14, v37
v_and_b32 v38, s14, v38
v_and_b32 v39, s14, v39
s_cbranch_vccz PX_118
s_mov_b64 exec, vcc
s_sub_u32 s16, s16, 1
s_cbranch_scc0 PT_129
s_branch PX_118
PT_130:
buffer_load_dwordx4 v[40:43], v12, s[76:79], s34 offen sc1
s_waitcnt vmcnt(0)
v_bitop3_b32 v11, v40, v41, v1 bitop3:0x7e
v_bitop3_b32 v11, v11, v42, v1 bitop3:0xf6
v_bitop3_b32 v11, v11, v43, v1 bitop3:0xf6
v_and_b32 v11, s15, v11
v_cmp_ne_u32 vcc, 0, v11
v_and_b32 v40, s14, v40
v_and_b32 v41, s14, v41
v_and_b32 v42, s14, v42
v_and_b32 v43, s14, v43
s_cbranch_vccz PX_118
s_mov_b64 exec, vcc
s_sub_u32 s16, s16, 1
s_cbranch_scc0 PT_130
PX_118:
s_mov_b64 exec, -1
PD_132:
L_PAD1:
s_cbranch_execz L_PAD2
v_pk_add_f32 v[32:33], v[32:33], v[36:37]
v_pk_add_f32 v[34:35], v[34:35], v[38:39]
v_pk_add_f32 v[40:41], v[40:41], v[44:45]
v_pk_add_f32 v[42:43], v[42:43], v[46:47]
v_pk_add_f32 v[32:33], v[32:33], v[40:41]
v_pk_add_f32 v[34:35], v[34:35], v[42:43]
s_nop 1
v_permlane32_swap_b32 v32, v34
v_permlane32_swap_b32 v33, v35
v_pk_add_f32 v[16:17], v[16:17], v[34:35]
v_pk_add_f32 v[16:17], v[16:17], v[32:33]
v_cvt_pk_bf16_f32 v11, v16, v17
s_nop 1
v_mov_b32_dpp v32, v11 row_newbcast:0 row_mask:0xf bank_mask:0xf
v_mov_b32_dpp v33, v11 row_newbcast:1 row_mask:0xf bank_mask:0xf
v_mov_b32_dpp v34, v11 row_newbcast:2 row_mask:0xf bank_mask:0xf
v_mov_b32_dpp v35, v11 row_newbcast:3 row_mask:0xf bank_mask:0xf
s_nop 1
v_mfma_f32_16x16x32_bf16 v[16:19], v[48:51], v[32:35], 0
v_mov_b32_dpp v36, v11 row_newbcast:4 row_mask:0xf bank_mask:0xf
v_mov_b32_dpp v37, v11 row_newbcast:5 row_mask:0xf bank_mask:0xf
v_mfma_f32_16x16x32_bf16 v[20:23], v[64:67], v[32:35], 0
v_mov_b32_dpp v38, v11 row_newbcast:6 row_mask:0xf bank_mask:0xf
v_mov_b32_dpp v39, v11 row_newbcast:7 row_mask:0xf bank_mask:0xf
v_mfma_f32_16x16x32_bf16 v[24:27], v[80:83], v[32:35], 0
v_mfma_f32_16x16x32_bf16 v[28:31], v[96:99], v[32:35], 0
v_mfma_f32_16x16x32_bf16 v[16:19], v[52:55], v[36:39], v[16:19]
v_mov_b32_dpp v40, v11 row_newbcast:8 row_mask:0xf bank_mask:0xf
v_mov_b32_dpp v41, v11 row_newbcast:9 row_mask:0xf bank_mask:0xf
v_mfma_f32_16x16x32_bf16 v[20:23], v[68:71], v[36:39], v[20:23]
v_mov_b32_dpp v42, v11 row_newbcast:10 row_mask:0xf bank_mask:0xf
v_mov_b32_dpp v43, v11 row_newbcast:11 row_mask:0xf bank_mask:0xf
v_mfma_f32_16x16x32_bf16 v[24:27], v[84:87], v[36:39], v[24:27]
v_mfma_f32_16x16x32_bf16 v[28:31], v[100:103], v[36:39], v[28:31]
v_mfma_f32_16x16x32_bf16 v[16:19], v[56:59], v[40:43], v[16:19]
v_mov_b32_dpp v44, v11 row_newbcast:12 row_mask:0xf bank_mask:0xf
v_mov_b32_dpp v45, v11 row_newbcast:13 row_mask:0xf bank_mask:0xf
v_mfma_f32_16x16x32_bf16 v[20:23], v[72:75], v[40:43], v[20:23]
v_mov_b32_dpp v46, v11 row_newbcast:14 row_mask:0xf bank_mask:0xf
v_mov_b32_dpp v47, v11 row_newbcast:15 row_mask:0xf bank_mask:0xf
v_mfma_f32_16x16x32_bf16 v[24:27], v[88:91], v[40:43], v[24:27]
v_mfma_f32_16x16x32_bf16 v[28:31], v[104:107], v[40:43], v[28:31]
v_mfma_f32_16x16x32_bf16 v[16:19], v[60:63], v[44:47], v[16:19]
v_mfma_f32_16x16x32_bf16 v[20:23], v[76:79], v[44:47], v[20:23]
v_mfma_f32_16x16x32_bf16 v[24:27], v[92:95], v[44:47], v[24:27]
v_mfma_f32_16x16x32_bf16 v[28:31], v[108:111], v[44:47], v[28:31]
v_lshlrev_b32 v11, 4, v15
s_lshl_b32 s20, s3, 8
v_add_u32 v11, s20, v11
s_mov_b32 exec_lo, 0x00010001
s_mov_b32 exec_hi, 0x00010001
ds_write_b128 v11, v[16:19] offset:24832
ds_write_b128 v11, v[20:23] offset:24896
ds_write_b128 v11, v[24:27] offset:24960
ds_write_b128 v11, v[28:31] offset:25024
s_mov_b64 exec, -1
s_lshl_b32 s20, s6, 8
s_mul_i32 s21, s8, 1792
s_add_u32 s20, s20, s21
s_add_u32 s20, s20, 786432
v_lshlrev_b32 v11, 4, v0
s_cmp_eq_u32 s3, 0
s_waitcnt lgkmcnt(0)
s_barrier
s_cbranch_scc0 L_T2
s_mov_b64 exec, 0xffff
ds_read_b128 v[16:19], v11 offset:24832
ds_read_b128 v[20:23], v11 offset:25088
ds_read_b128 v[24:27], v11 offset:25344
ds_read_b128 v[28:31], v11 offset:25600
s_waitcnt lgkmcnt(2)
v_pk_add_f32 v[16:17], v[16:17], v[20:21]
v_pk_add_f32 v[18:19], v[18:19], v[22:23]
s_waitcnt lgkmcnt(0)
v_pk_add_f32 v[24:25], v[24:25], v[28:29]
v_pk_add_f32 v[26:27], v[26:27], v[30:31]
v_pk_add_f32 v[16:17], v[16:17], v[24:25]
v_pk_add_f32 v[18:19], v[18:19], v[26:27]
v_bfi_b32 v16, s15, v1, v16
v_bfi_b32 v17, s15, v1, v17
v_bfi_b32 v18, s15, v1, v18
v_bfi_b32 v19, s15, v1, v19
buffer_store_dwordx4 v[16:19], v11, s[76:79], s20 offen sc1
s_add_u32 s20, s20, 65536
buffer_store_dwordx4 v[16:19], v11, s[76:79], s20 offen
s_mov_b64 exec, -1
L_T2:
v_and_b32 v12, 31, v0
s_mul_i32 s20, s3, 28
v_add_u32 v13, s20, v12
v_lshrrev_b32 v12, 5, v0
v_mul_u32_u24 v12, 7168, v12
v_lshl_add_u32 v12, v13, 4, v12
s_mul_i32 s22, s10, 14336
s_add_u32 s22, s22, 786432
s_add_u32 s23, s22, 3584
s_cmp_eq_u32 s36, 1
s_cselect_b32 s37, 65536, 0
s_bitcmp1_b32 s11, 2
s_cselect_b32 s38, 0, -1
s_not_b32 s39, s38
v_mov_b32 v33, s37
v_cndmask_b32 v33, 0, v33, s[38:39]
L_PAD2:
s_cbranch_execz L_PAD3
v_add_u32 v33, v33, v12
s_and_b32 s21, s11, 3
s_cmp_eq_u32 s21, 0
s_cselect_b64 s[38:39], -1, 0
v_cndmask_b32 v32, v12, v33, s[38:39]
s_cmp_eq_u32 s21, 2
s_cselect_b64 s[38:39], -1, 0
v_cndmask_b32 v34, v12, v33, s[38:39]
s_cmp_eq_u32 s21, 3
s_cselect_b64 s[38:39], -1, 0
v_cndmask_b32 v35, v12, v33, s[38:39]
s_cmp_eq_u32 s21, 1
s_cselect_b64 s[38:39], -1, 0
v_cndmask_b32 v33, v12, v33, s[38:39]
v_mov_b32 v48, 0
v_mov_b32 v49, 0
v_mov_b32 v50, 0
v_mov_b32 v51, 0
v_mov_b32 v52, 0
v_mov_b32 v53, 0
v_mov_b32 v54, 0
v_mov_b32 v55, 0
v_mov_b32 v56, 0
v_mov_b32 v57, 0
v_mov_b32 v58, 0
v_mov_b32 v59, 0
v_mov_b32 v60, 0
v_mov_b32 v61, 0
v_mov_b32 v62, 0
v_mov_b32 v63, 0
s_mov_b32 exec_lo, 0x0fffffff
s_mov_b32 exec_hi, 0x0fffffff
s_mov_b64 s[24:25], exec
s_mov_b64 s[26:27], exec
s_mov_b64 s[28:29], exec
s_mov_b64 s[30:31], exec
s_mov_b32 s16, 40000
PL_136:
s_mov_b64 exec, s[24:25]
s_cbranch_execz PS_137
buffer_load_dwordx4 v[48:51], v32, s[76:79], s22 offen offset:0 sc1
PS_137:
s_mov_b64 exec, s[26:27]
s_cbranch_execz PS_138
buffer_load_dwordx4 v[52:55], v33, s[76:79], s22 offen offset:1792 sc1
PS_138:
s_mov_b64 exec, s[28:29]
s_cbranch_execz PS_139
buffer_load_dwordx4 v[56:59], v34, s[76:79], s23 offen offset:0 sc1
PS_139:
s_mov_b64 exec, s[30:31]
s_cbranch_execz PS_140
buffer_load_dwordx4 v[60:63], v35, s[76:79], s23 offen offset:1792 sc1
PS_140:
s_mov_b64 exec, -1
v_and_b32 v104, 3, v0
v_lshrrev_b32 v105, 2, v0
v_lshlrev_b32 v106, 11, v105
v_lshl_add_u32 v106, v104, 4, v106
s_cmp_eq_u32 s36, 1
s_cselect_b32 s37, 524288, 0
s_mul_i32 s38, s11, 7
v_subrev_u32 v105, s38, v105
v_mov_b32 v104, s37
s_mov_b32 s38, -1
s_mov_b32 s39, 0
v_mov_b32 v47, s14
v_cndmask_b32 v47, 0, v47, s[38:39]
v_add_u32 v103, 0, v105
v_cmp_gt_u32 vcc, 7, v103
s_nop 1
v_cndmask_b32 v103, 0, v104, vcc
v_add_u32 v108, v103, v106
v_add_u32 v103, 16, v105
v_cmp_gt_u32 vcc, 7, v103
s_nop 1
v_cndmask_b32 v103, 0, v104, vcc
v_add_u32 v109, v103, v106
v_add_u32 v103, 32, v105
v_cmp_gt_u32 vcc, 7, v103
s_nop 1
v_cndmask_b32 v103, 0, v104, vcc
v_add_u32 v110, v103, v106
v_add_u32 v103, 48, v105
v_cmp_gt_u32 vcc, 7, v103
s_nop 1
v_cndmask_b32 v103, 0, v104, vcc
v_add_u32 v111, v103, v106
v_lshrrev_b32 v43, 5, v0
v_lshlrev_b32 v36, 2, v43
s_lshl_b32 s20, s3, 3
v_add_u32 v36, s20, v36
v_lshlrev_b32 v38, 1, v43
v_lshl_add_u32 v38, v13, 2, v38
v_lshlrev_b32 v37, 2, v38
v_lshlrev_b32 v38, 1, v38
v_mov_b32 v39, 0
s_lshr_b32 s20, s3, 1
s_mul_i32 s20, s20, 448
v_lshlrev_b32 v42, 4, v15
v_add_u32 v40, s20, v42
s_lshl_b32 s20, s3, 6
v_add_u32 v41, s20, v42
v_lshlrev_b32 v43, 4, v0
s_lshl_b32 s20, s3, 9
v_add_u32 v43, s20, v43
s_mul_i32 s20, s10, 56
s_add_u32 s20, s20, s12
s_lshl_b32 s20, s20, 11
s_add_u32 s20, s20, 1048576
s_mov_b32 s84, 0xffff0000
s_mov_b32 s85, 0
s_branch PW_135
PL_133:
s_mov_b64 exec, s[24:25]
s_cbranch_execz PS_141
buffer_load_dwordx4 v[48:51], v32, s[76:79], s22 offen offset:0 sc1
PS_141:
s_mov_b64 exec, s[26:27]
s_cbranch_execz PS_142
buffer_load_dwordx4 v[52:55], v33, s[76:79], s22 offen offset:1792 sc1
PS_142:
s_mov_b64 exec, s[28:29]
s_cbranch_execz PS_143
buffer_load_dwordx4 v[56:59], v34, s[76:79], s23 offen offset:0 sc1
PS_143:
s_mov_b64 exec, s[30:31]
s_cbranch_execz PS_144
buffer_load_dwordx4 v[60:63], v35, s[76:79], s23 offen offset:1792 sc1
PS_144:
PW_135:
s_waitcnt vmcnt(0)
s_mov_b64 exec, s[24:25]
s_cbranch_execz PS_145
v_bitop3_b32 v44, v48, v49, v1 bitop3:0x7e
v_bitop3_b32 v44, v44, v50, v1 bitop3:0xf6
v_bitop3_b32 v44, v44, v51, v1 bitop3:0xf6
v_and_b32 v44, s15, v44
v_cmp_ne_u32 s[24:25], 0, v44
v_and_b32 v48, s14, v48
v_and_b32 v49, s14, v49
v_and_b32 v50, s14, v50
v_and_b32 v51, s14, v51
PS_145:
s_mov_b64 exec, s[26:27]
s_cbranch_execz PS_146
v_bitop3_b32 v44, v52, v53, v1 bitop3:0x7e
v_bitop3_b32 v44, v44, v54, v1 bitop3:0xf6
v_bitop3_b32 v44, v44, v55, v1 bitop3:0xf6
v_and_b32 v44, s15, v44
v_cmp_ne_u32 s[26:27], 0, v44
v_and_b32 v52, s14, v52
v_and_b32 v53, s14, v53
v_and_b32 v54, s14, v54
v_and_b32 v55, s14, v55
PS_146:
s_mov_b64 exec, s[28:29]
s_cbranch_execz PS_147
v_bitop3_b32 v44, v56, v57, v1 bitop3:0x7e
v_bitop3_b32 v44, v44, v58, v1 bitop3:0xf6
v_bitop3_b32 v44, v44, v59, v1 bitop3:0xf6
v_and_b32 v44, s15, v44
v_cmp_ne_u32 s[28:29], 0, v44
v_and_b32 v56, s14, v56
v_and_b32 v57, s14, v57
v_and_b32 v58, s14, v58
v_and_b32 v59, s14, v59
PS_147:
s_mov_b64 exec, s[30:31]
s_cbranch_execz PS_148
v_bitop3_b32 v44, v60, v61, v1 bitop3:0x7e
v_bitop3_b32 v44, v44, v62, v1 bitop3:0xf6
v_bitop3_b32 v44, v44, v63, v1 bitop3:0xf6
v_and_b32 v44, s15, v44
v_cmp_ne_u32 s[30:31], 0, v44
v_and_b32 v60, s14, v60
v_and_b32 v61, s14, v61
v_and_b32 v62, s14, v62
v_and_b32 v63, s14, v63
PS_148:
s_or_b64 s[0:1], s[24:25], s[26:27]
s_or_b64 s[0:1], s[0:1], s[28:29]
s_or_b64 s[0:1], s[0:1], s[30:31]
s_cbranch_scc0 PX_134
s_sub_u32 s16, s16, 1
s_cbranch_scc1 PX_134
s_cmp_lg_u64 s[24:25], 0
s_cselect_b32 s17, 1, 0
s_cmp_lg_u64 s[26:27], 0
s_addc_u32 s17, s17, 0
s_cmp_lg_u64 s[28:29], 0
s_addc_u32 s17, s17, 0
s_cmp_lg_u64 s[30:31], 0
s_addc_u32 s17, s17, 0
s_cmp_eq_u32 s17, 1
s_cbranch_scc0 PL_133
s_mov_b64 exec, s[24:25]
s_cbranch_execnz PT_149
s_mov_b64 exec, s[26:27]
s_cbranch_execnz PT_150
s_mov_b64 exec, s[28:29]
s_cbranch_execnz PT_151
s_mov_b64 exec, s[30:31]
PT_152:
buffer_load_dwordx4 v[60:63], v35, s[76:79], s23 offen offset:1792 sc1
s_waitcnt vmcnt(0)
v_bitop3_b32 v44, v60, v61, v1 bitop3:0x7e
v_bitop3_b32 v44, v44, v62, v1 bitop3:0xf6
v_bitop3_b32 v44, v44, v63, v1 bitop3:0xf6
v_and_b32 v44, s15, v44
v_cmp_ne_u32 vcc, 0, v44
v_and_b32 v60, s14, v60
v_and_b32 v61, s14, v61
v_and_b32 v62, s14, v62
v_and_b32 v63, s14, v63
s_cbranch_vccz PX_134
s_mov_b64 exec, vcc
s_sub_u32 s16, s16, 1
s_cbranch_scc0 PT_152
s_branch PX_134
PT_149:
buffer_load_dwordx4 v[48:51], v32, s[76:79], s22 offen offset:0 sc1
s_waitcnt vmcnt(0)
v_bitop3_b32 v44, v48, v49, v1 bitop3:0x7e
v_bitop3_b32 v44, v44, v50, v1 bitop3:0xf6
v_bitop3_b32 v44, v44, v51, v1 bitop3:0xf6
v_and_b32 v44, s15, v44
v_cmp_ne_u32 vcc, 0, v44
v_and_b32 v48, s14, v48
v_and_b32 v49, s14, v49
v_and_b32 v50, s14, v50
v_and_b32 v51, s14, v51
s_cbranch_vccz PX_134
s_mov_b64 exec, vcc
s_sub_u32 s16, s16, 1
s_cbranch_scc0 PT_149
s_branch PX_134
PT_150:
buffer_load_dwordx4 v[52:55], v33, s[76:79], s22 offen offset:1792 sc1
s_waitcnt vmcnt(0)
v_bitop3_b32 v44, v52, v53, v1 bitop3:0x7e
v_bitop3_b32 v44, v44, v54, v1 bitop3:0xf6
v_bitop3_b32 v44, v44, v55, v1 bitop3:0xf6
v_and_b32 v44, s15, v44
v_cmp_ne_u32 vcc, 0, v44
v_and_b32 v52, s14, v52
v_and_b32 v53, s14, v53
v_and_b32 v54, s14, v54
v_and_b32 v55, s14, v55
s_cbranch_vccz PX_134
s_mov_b64 exec, vcc
s_sub_u32 s16, s16, 1
s_cbranch_scc0 PT_150
s_branch PX_134
PT_151:
buffer_load_dwordx4 v[56:59], v34, s[76:79], s23 offen offset:0 sc1
s_waitcnt vmcnt(0)
v_bitop3_b32 v44, v56, v57, v1 bitop3:0x7e
v_bitop3_b32 v44, v44, v58, v1 bitop3:0xf6
v_bitop3_b32 v44, v44, v59, v1 bitop3:0xf6
v_and_b32 v44, s15, v44
v_cmp_ne_u32 vcc, 0, v44
v_and_b32 v56, s14, v56
v_and_b32 v57, s14, v57
v_and_b32 v58, s14, v58
v_and_b32 v59, s14, v59
s_cbranch_vccz PX_134
s_mov_b64 exec, vcc
s_sub_u32 s16, s16, 1
s_cbranch_scc0 PT_151
PX_134:
s_mov_b64 exec, -1
PD_153:
L_PAD3:
s_cbranch_execz L_PAD4
v_pk_add_f32 v[48:49], v[48:49], v[52:53]
v_pk_add_f32 v[50:51], v[50:51], v[54:55]
v_pk_add_f32 v[56:57], v[56:57], v[60:61]
v_pk_add_f32 v[58:59], v[58:59], v[62:63]
v_pk_add_f32 v[48:49], v[48:49], v[56:57]
v_pk_add_f32 v[50:51], v[50:51], v[58:59]
s_nop 1
v_permlane32_swap_b32 v48, v50
v_permlane32_swap_b32 v49, v51
v_pk_add_f32 v[16:17], v[48:49], v[50:51]
v_cvt_pk_bf16_f32 v18, v16, v17
v_lshlrev_b32 v16, 16, v18
v_and_b32 v17, s81, v18
v_pk_mul_f32 v[16:17], v[16:17], v[2:3]
v_cvt_pk_bf16_f32 v18, v16, v17
v_lshlrev_b32 v16, 16, v18
v_and_b32 v17, s81, v18
v_pk_add_f32 v[16:17], v[16:17], v[8:9]
v_cvt_pk_bf16_f32 v18, v16, v17
v_lshlrev_b32 v16, 16, v18
v_and_b32 v17, s81, v18
v_add_f32 v18, v16, v17
v_mul_f32 v19, v16, v16
v_fmac_f32 v19, v17, v17
s_nop 1
v_permlane32_swap_b32 v18, v19
v_add_f32 v18, v18, v19
v_mov_b32 v19, v18
s_nop 1
v_permlane16_swap_b32 v19, v18
v_add_f32 v18, v18, v19
s_nop 1
v_add_f32_dpp v18, v18, v18 quad_perm:[1,0,3,2] row_mask:0xf bank_mask:0xf
s_nop 1
v_add_f32_dpp v18, v18, v18 quad_perm:[2,3,0,1] row_mask:0xf bank_mask:0xf
s_nop 1
v_add_f32_dpp v18, v18, v18 row_half_mirror row_mask:0xf bank_mask:0xf
s_nop 1
v_add_f32_dpp v18, v18, v18 row_mirror row_mask:0xf bank_mask:0xf
s_mov_b32 exec_lo, 1
s_mov_b32 exec_hi, 1
ds_write_b32 v36, v18 offset:25856
s_mov_b32 exec_lo, 0x0fffffff
s_mov_b32 exec_hi, 0x0fffffff
ds_write_b64 v37, v[16:17] offset:26816
s_waitcnt lgkmcnt(0)
s_barrier
ds_read_b128 v[24:27], v39 offset:25856
ds_read_b128 v[28:31], v39 offset:25872
s_waitcnt lgkmcnt(0)
v_pk_add_f32 v[24:25], v[24:25], v[28:29]
v_pk_add_f32 v[26:27], v[26:27], v[30:31]
v_pk_add_f32 v[24:25], v[24:25], v[26:27]
v_mul_f32 v24, 0x3b124925, v24
v_mul_f32 v25, 0x3b124925, v25
v_fma_f32 v25, -v24, v24, v25
v_max_f32 v25, 0, v25
v_cvt_pk_bf16_f32 v25, v24, v25
v_lshlrev_b32 v24, 16, v25
v_and_b32 v25, s81, v25
v_add_f32 v25, 0x3727c5ac, v25
v_cvt_pk_bf16_f32 v25, v25, v25
v_and_b32 v25, s81, v25
v_sqrt_f32 v25, v25
s_nop 0
v_cvt_pk_bf16_f32 v25, v25, v25
v_and_b32 v25, s81, v25
v_rcp_f32 v25, v25
v_sub_f32 v16, v16, v24
v_sub_f32 v17, v17, v24
v_cvt_pk_bf16_f32 v18, v16, v17
v_lshlrev_b32 v16, 16, v18
v_and_b32 v17, s81, v18
v_mul_f32 v16, v16, v25
v_mul_f32 v17, v17, v25
v_cvt_pk_bf16_f32 v18, v16, v17
v_lshlrev_b32 v16, 16, v18
v_and_b32 v17, s81, v18
v_pk_mul_f32 v[16:17], v[16:17], v[4:5]
v_cvt_pk_bf16_f32 v18, v16, v17
v_lshlrev_b32 v16, 16, v18
v_and_b32 v17, s81, v18
v_pk_add_f32 v[16:17], v[16:17], v[6:7]
v_cvt_pk_bf16_f32 v18, v16, v17
ds_write_b32 v38, v18 offset:25920
s_mov_b64 exec, -1
s_waitcnt lgkmcnt(0)
s_barrier
ds_read_b128 v[80:83], v40 offset:25920
ds_read_b128 v[84:87], v40 offset:25984
ds_read_b128 v[88:91], v40 offset:26048
ds_read_b128 v[92:95], v40 offset:26112
ds_read_b128 v[96:99], v40 offset:26176
ds_read_b128 v[100:103], v40 offset:26240
ds_read_b128 v[104:107], v40 offset:26304
s_waitcnt lgkmcnt(6)
v_mfma_f32_16x16x32_bf16 v[16:19], v[112:115], v[80:83], 0
s_waitcnt lgkmcnt(5)
v_mfma_f32_16x16x32_bf16 v[20:23], v[116:119], v[84:87], 0
s_waitcnt lgkmcnt(4)
v_mfma_f32_16x16x32_bf16 v[16:19], v[120:123], v[88:91], v[16:19]
s_waitcnt lgkmcnt(3)
v_mfma_f32_16x16x32_bf16 v[20:23], v[124:127], v[92:95], v[20:23]
s_waitcnt lgkmcnt(2)
v_mfma_f32_16x16x32_bf16 v[16:19], v[128:131], v[96:99], v[16:19]
s_waitcnt lgkmcnt(1)
v_mfma_f32_16x16x32_bf16 v[20:23], v[132:135], v[100:103], v[20:23]
s_waitcnt lgkmcnt(0)
v_mfma_f32_16x16x32_bf16 v[16:19], v[136:139], v[104:107], v[16:19]
s_mov_b32 exec_lo, 0x00010001
s_mov_b32 exec_hi, 0x00010001
s_nop 5
v_pk_add_f32 v[16:17], v[16:17], v[20:21]
v_pk_add_f32 v[18:19], v[18:19], v[22:23]
ds_write_b128 v41, v[16:19] offset:28608
s_mov_b64 exec, -1
L_PAD4:
s_cbranch_execz L_PAD5
s_waitcnt lgkmcnt(0)
s_barrier
ds_read_b128 v[16:19], v42 offset:28608
ds_read_b128 v[20:23], v42 offset:28672
ds_read_b128 v[24:27], v42 offset:28736
ds_read_b128 v[28:31], v42 offset:28800
s_waitcnt lgkmcnt(1)
v_pk_add_f32 v[16:17], v[16:17], v[24:25]
v_pk_add_f32 v[18:19], v[18:19], v[26:27]
s_waitcnt lgkmcnt(0)
v_pk_add_f32 v[20:21], v[20:21], v[28:29]
v_pk_add_f32 v[22:23], v[22:23], v[30:31]
v_cvt_pk_bf16_f32 v24, v16, v17
v_cvt_pk_bf16_f32 v25, v18, v19
v_cvt_pk_bf16_f32 v26, v20, v21
v_cvt_pk_bf16_f32 v27, v22, v23
v_pk_max_i16 v24, v24, 0
v_pk_max_i16 v25, v25, 0
v_pk_max_i16 v26, v26, 0
v_pk_max_i16 v27, v27, 0
s_nop 1
v_mfma_f32_16x16x32_bf16 v[80:83], v[24:27], v[140:143], 0
v_mfma_f32_16x16x32_bf16 v[84:87], v[24:27], v[144:147], 0
v_mfma_f32_16x16x32_bf16 v[88:91], v[24:27], v[148:151], 0
v_mfma_f32_16x16x32_bf16 v[92:95], v[24:27], v[152:155], 0
v_mfma_f32_16x16x32_bf16 v[96:99], v[24:27], v[156:159], 0
v_mfma_f32_16x16x32_bf16 v[100:103], v[24:27], v[160:163], 0
v_mfma_f32_16x16x32_bf16 v[104:107], v[24:27], v[164:167], 0
s_mov_b32 exec_lo, -1
s_mov_b32 exec_hi, 0
s_nop 3
v_cndmask_b32 v16, v80, v96, s[84:85]
v_cndmask_b32 v17, v84, v100, s[84:85]
v_cndmask_b32 v18, v88, v104, s[84:85]
v_bfi_b32 v16, s15, v1, v16
v_bfi_b32 v17, s15, v1, v17
v_bfi_b32 v18, s15, v1, v18
v_bfi_b32 v19, s15, v1, v92
buffer_store_dwordx4 v[16:19], v43, s[76:79], s20 offen sc1
s_add_u32 s20, s20, 524288
buffer_store_dwordx4 v[16:19], v43, s[76:79], s20 offen
s_mov_b64 exec, -1
s_cmp_eq_u32 s18, 0
s_cbranch_scc1 L_HEND
s_mul_i32 s20, s10, 114688
s_lshl_b32 s21, s12, 6
s_add_u32 s20, s20, s21
s_add_u32 s20, s20, 1048576
s_add_u32 s21, s20, 0x8000
s_add_u32 s22, s20, 0x10000
s_add_u32 s23, s20, 0x18000
s_mov_b64 s[24:25], -1
s_mov_b64 s[26:27], -1
s_mov_b64 s[28:29], -1
s_mov_b32 s30, -1
s_mov_b32 s31, 0
v_and_b32 v11, 3, v0
v_lshl_add_u32 v13, v15, 4, v11
v_add_u32 v13, s19, v13
v_lshlrev_b32 v16, 2, v13
ds_read_b32 v17, v16 offset:26816
v_lshlrev_b32 v13, 1, v13
s_mul_i32 s19, s10, 896
s_and_b32 s83, s83, 0x000f000f
s_mov_b32 s38, 0
s_mov_b32 s39, -1
v_cndmask_b32 v111, v111, v110, s[38:39]
v_mov_b32 v16, 0x8000
v_cndmask_b32 v16, v16, 0, s[38:39]
v_add_u32 v111, v111, v16
s_mov_b32 s16, 40000
s_mov_b64 s[0:1], exec
PL_154:
buffer_load_dwordx4 v[112:115], v108, s[76:79], s20 offen sc1
buffer_load_dwordx4 v[116:119], v109, s[76:79], s21 offen sc1
buffer_load_dwordx4 v[120:123], v110, s[76:79], s22 offen sc1
buffer_load_dwordx4 v[124:127], v111, s[76:79], s22 offen sc1
s_waitcnt vmcnt(0)
v_bitop3_b32 v44, v112, v113, v1 bitop3:0x7e
v_bitop3_b32 v44, v44, v114, v1 bitop3:0xf6
v_bitop3_b32 v44, v44, v115, v1 bitop3:0xf6
v_bitop3_b32 v44, v44, v116, v1 bitop3:0xf6
v_bitop3_b32 v44, v44, v117, v1 bitop3:0xf6
v_bitop3_b32 v44, v44, v118, v1 bitop3:0xf6
v_bitop3_b32 v44, v44, v119, v1 bitop3:0xf6
v_bitop3_b32 v44, v44, v120, v1 bitop3:0xf6
v_bitop3_b32 v44, v44, v121, v1 bitop3:0xf6
v_bitop3_b32 v44, v44, v122, v1 bitop3:0xf6
v_bitop3_b32 v44, v44, v123, v1 bitop3:0xf6
v_bitop3_b32 v44, v44, v124, v1 bitop3:0xf6
v_bitop3_b32 v44, v44, v125, v1 bitop3:0xf6
v_bitop3_b32 v44, v44, v126, v1 bitop3:0xf6
v_bitop3_b32 v44, v44, v127, v1 bitop3:0xf6
v_and_b32 v44, s15, v44
v_cmp_ne_u32 vcc, 0, v44
s_cbranch_vccz PD_155
s_mov_b64 exec, vcc
s_sub_u32 s16, s16, 1
s_cbranch_scc0 PL_154
PD_155:
s_mov_b64 exec, s[0:1]
v_and_b32 v20, s14, v112
L_PAD5:
s_cbranch_execz L_PAD6
v_and_b32 v21, s14, v113
v_and_b32 v22, s14, v114
v_and_b32 v23, s14, v115
v_and_b32 v24, s14, v116
v_and_b32 v25, s14, v117
v_and_b32 v26, s14, v118
v_and_b32 v27, s14, v119
v_and_b32 v28, s14, v120
v_and_b32 v29, s14, v121
v_and_b32 v30, s14, v122
v_and_b32 v31, s14, v123
v_and_b32 v32, v47, v124
v_and_b32 v33, v47, v125
v_and_b32 v34, v47, v126
v_and_b32 v35, v47, v127
v_pk_add_f32 v[20:21], v[20:21], v[24:25]
v_pk_add_f32 v[22:23], v[22:23], v[26:27]
v_pk_add_f32 v[28:29], v[28:29], v[32:33]
v_pk_add_f32 v[30:31], v[30:31], v[34:35]
v_pk_add_f32 v[20:21], v[20:21], v[28:29]
v_pk_add_f32 v[22:23], v[22:23], v[30:31]
s_nop 1
v_permlane32_swap_b32 v20, v22
v_permlane32_swap_b32 v21, v23
v_pk_add_f32 v[20:21], v[20:21], v[22:23]
s_nop 1
v_permlane16_swap_b32 v20, v21
v_add_f32 v20, v20, v21
s_nop 1
v_add_f32_dpp v20, v20, v20 row_ror:4 row_mask:0xf bank_mask:0xf
s_nop 1
v_add_f32_dpp v20, v20, v20 row_ror:8 row_mask:0xf bank_mask:0xf
v_cvt_pk_bf16_f32 v20, v20, v20
v_and_b32 v20, s81, v20
v_mul_f32 v20, v20, v10
v_cvt_pk_bf16_f32 v20, v20, v20
v_and_b32 v20, s81, v20
s_waitcnt lgkmcnt(0)
v_add_f32 v20, v20, v17
v_cvt_pk_bf16_f32 v20, v20, v20
L_PAD6:
s_cbranch_execz L_WARMR
s_mov_b32 exec_lo, 0x000f000f
s_mov_b32 exec_hi, s83
buffer_store_short v20, v13, s[72:75], s19 offen
s_branch L_HEND
L_FEND:
s_cmp_eq_u32 s2, 0
s_cbranch_scc0 L_HEND
s_cmp_eq_u32 s3, 0
s_cbranch_scc0 L_HEND
s_mov_b32 s20, 114688
v_mul_lo_u32 v12, v0, s20
s_mov_b32 s20, 1048576
s_mov_b64 exec, 15
s_mov_b32 s16, 40000
s_mov_b64 s[0:1], exec
PL_156:
buffer_load_dwordx4 v[20:23], v12, s[76:79], s20 offen sc1
s_waitcnt vmcnt(0)
v_bitop3_b32 v44, v20, v21, v1 bitop3:0x7e
v_bitop3_b32 v44, v44, v22, v1 bitop3:0xf6
v_bitop3_b32 v44, v44, v23, v1 bitop3:0xf6
v_and_b32 v44, s15, v44
v_cmp_ne_u32 vcc, 0, v44
s_cbranch_vccz PD_157
s_mov_b64 exec, vcc
s_sub_u32 s16, s16, 1
s_cbranch_scc0 PL_156
PD_157:
s_mov_b64 exec, s[0:1]
s_mov_b64 exec, 1
v_mov_b32 v20, s13
buffer_store_dword v20, v12, s[76:79], 0 offen sc1
L_HEND:
L_END:
s_endpgm
.section .rodata,"a"
.p2align 6
.amdhsa_kernel adaLN_cond__gqa_block_cached__dense_activation_relu__decode_kernel
  .amdhsa_next_free_vgpr 168
  .amdhsa_next_free_sgpr 102
  .amdhsa_accum_offset 168
  .amdhsa_group_segment_fixed_size 0
  .amdhsa_kernarg_size 104
  .amdhsa_user_sgpr_count 2
  .amdhsa_user_sgpr_kernarg_segment_ptr 1
  .amdhsa_system_sgpr_workgroup_id_x 1
.end_amdhsa_kernel
```
